```python
import torch

def _softmax(x, axis=-1):
    return torch.softmax(x, dim=axis)
def _gelu(x):
    return torch.nn.functional.gelu(x, approximate="tanh")
def _silu(x):
    return torch.nn.functional.silu(x)
def _sigmoid(x):
    return torch.sigmoid(x)
def _layernorm(x, axis=-1, eps=1e-5):
    m = x.mean(dim=axis, keepdim=True)
    v = x.var(dim=axis, keepdim=True, unbiased=False)
    return (x - m) / torch.sqrt(v + eps)
def _scatter_add(tgt, idx, src, axis=0):
    return tgt.clone().index_add_(axis, idx, src)
def _segment_sum(src, seg, n):
    out = torch.zeros((n,) + src.shape[1:], dtype=src.dtype)
    return out.index_add_(0, seg, src)
def _pad(x, pw):
    flat = tuple(v for pair in reversed(pw) for v in pair)
    return torch.nn.functional.pad(x, flat)

kernel_name = 'sequential_preLN__linear_kernel_hedgehog__dense_activation_relu__prompt'

def setup_inputs():

    _w = (lambda a: (lambda t: t.to(torch.bfloat16) if t.is_floating_point() else t)(torch.as_tensor(a)))
    def _A_setup():
        B, S, D, H = 1, 2048, 640, 32
        Dh = D // H
        return {
            "x": _w((lambda *s: torch.randn(*s, dtype=torch.bfloat16) * 0.05)(B, S, D)),
            "wqkv": _w((lambda *s: torch.randn(*s, dtype=torch.bfloat16) * 0.2)(D, 3 * D)),
            "w_phi": _w((lambda *s: torch.randn(*s, dtype=torch.bfloat16) * 0.2)(H, Dh, Dh) * (Dh ** -0.5)),
            "wo": _w((lambda *s: torch.randn(*s, dtype=torch.bfloat16) * 0.05)(D, D)),
        }
    _A_in = _A_setup()

    def _B_setup():
        B, S, D, Dff = 1, 2048, 640, 1536
        return {
            "x": _w((lambda *s: torch.randn(*s, dtype=torch.bfloat16) * 0.05)(B, S, D)),
            "w1": _w((lambda *s: torch.randn(*s, dtype=torch.bfloat16) * 0.05)(D, Dff)),
            "w2": _w((lambda *s: torch.randn(*s, dtype=torch.bfloat16) * 0.05)(Dff, D)),
        }
    _B_in = _B_setup()

    return {
        "A_x": _A_in["x"],
        "A_wqkv": _A_in["wqkv"],
        "A_w_phi": _A_in["w_phi"],
        "A_wo": _A_in["wo"],
        "B_x": _B_in["x"],
        "B_w1": _B_in["w1"],
        "B_w2": _B_in["w2"],
    }

def reference(A_x, A_wqkv, A_w_phi, A_wo, B_x, B_w1, B_w2):
    def _A_ref(x, wqkv, w_phi, wo):
        B, S, D = x.shape
        H = 32; Dh = D // H
        qkv = (lambda x, *d: x.permute(*d))((x @ wqkv).reshape(B, S, 3, H, Dh), 2, 0, 3, 1, 4)
        q, k, v = qkv[0], qkv[1], qkv[2]
        pq = torch.einsum("bhsd,hdf->bhsf", q, w_phi)
        pk = torch.einsum("bhsd,hdf->bhsf", k, w_phi)
        phi_q = torch.concatenate([_softmax(pq, axis=-1), _softmax(-pq, axis=-1)], axis=-1)
        phi_k = torch.concatenate([_softmax(pk, axis=-1), _softmax(-pk, axis=-1)], axis=-1)
        kv = torch.einsum("bhsf,bhsd->bhfd", phi_k, v)
        z  = torch.einsum("bhsf->bhf", phi_k)
        num = torch.einsum("bhqf,bhfd->bhqd", phi_q, kv)
        den = torch.einsum("bhqf,bhf->bhq", phi_q, z)[..., None] + 1e-6
        o = num / den
        return (lambda x, *d: x.permute(*d))(o, 0, 2, 1, 3).reshape(B, S, D) @ wo

    def _B_ref(x, w1, w2):
        h = torch.einsum("bsd,df->bsf", x, w1)
        zero = torch.zeros_like(h)
        h = torch.maximum(h, zero)
        return torch.einsum("bsf,fd->bsd", h, w2)

    x = A_x
    h = x + _A_ref(_layernorm(x, axis=-1), A_wqkv, A_w_phi, A_wo)
    h2 = h + _B_ref(_layernorm(h, axis=-1), B_w1, B_w2)
    return h2
```

```asm
; @launch grid=(256,1,1) block=(256,1,1) lds=163840
.amdgcn_target "amdgcn-amd-amdhsa--gfx950"
.text
.globl sequential_preLN__linear_kernel_hedgehog__dense_activation_relu__prompt_kernel
.p2align 8
.type sequential_preLN__linear_kernel_hedgehog__dense_activation_relu__prompt_kernel,@function
sequential_preLN__linear_kernel_hedgehog__dense_activation_relu__prompt_kernel:
    s_cmp_ge_u32 s2, 256
    s_cbranch_scc0 L_start
    s_endpgm
L_start:
    s_load_dwordx2 s[24:25], s[0:1], 0
    s_load_dwordx2 s[28:29], s[0:1], 8
    s_load_dwordx2 s[32:33], s[0:1], 72
    s_load_dwordx2 s[52:53], s[0:1], 16
    s_load_dwordx2 s[56:57], s[0:1], 64
    s_load_dwordx2 s[44:45], s[0:1], 24
    s_load_dwordx2 s[36:37], s[0:1], 40
    s_load_dwordx2 s[40:41], s[0:1], 56
    s_load_dwordx2 s[20:21], s[0:1], 48
    s_getpc_b64 s[22:23]
    v_lshrrev_b32 v2, 6, v0
    v_and_b32 v0, 63, v0
    v_readfirstlane_b32 s3, v2
    v_lshlrev_b32 v1, 4, v0
    s_bfe_u32 s10, s2, 0x30003
    v_lshlrev_b32 v2, 7, v0
    s_lshl2_add_u32 s10, s10, s3
    s_mul_i32 s10, s10, 1280
    v_add_u32 v2, s10, v2
    v_min_u32 v2, L_code_end-L_start-256, v2
    s_mov_b64 exec, 0x3ff
    global_load_dword v231, v2, s[22:23]
    s_mov_b64 exec, -1
    s_and_b32 s10, s2, 7
    s_lshr_b32 s11, s2, 3
    s_and_b32 s12, s2, 1
    s_lshr_b32 s13, s11, 2
    s_lshl3_add_u32 s4, s12, s13
    s_and_b32 s12, s2, 6
    s_and_b32 s13, s11, 3
    s_lshl1_add_u32 s5, s12, s13
    s_lshr_b32 s12, s11, 2
    s_add_u32 s12, s12, s13
    s_bfe_u32 s13, s2, 0x20001
    s_add_u32 s12, s12, s13
    s_mul_i32 s13, s12, 13108
    s_lshr_b32 s13, s13, 16
    s_mul_i32 s13, s13, 5
    s_sub_u32 s101, s12, s13
    s_lshl_b32 s100, s101, 1
    v_lshrrev_b32 v25, 3, v0
    v_lshrrev_b32 v26, 4, v0
    v_and_b32 v27, 7, v0
    s_lshl2_add_u32 s12, s4, s3
    s_mul_i32 s12, s12, 40960
    v_mul_u32_u24 v25, 1280, v25
    v_xor_b32 v27, v27, v26
    v_add_u32 v25, s12, v25
    v_lshl_add_u32 v2, v27, 4, v25
    v_xor_b32 v27, 4, v27
    v_lshl_add_u32 v3, v27, 4, v25
    v_add_u32 v3, 10240, v3
    v_add_u32 v4, 20480, v2
    v_add_u32 v5, 20480, v3
    s_lshl_b32 s60, s3, 12
    s_mul_i32 s61, s3, 2560
    s_add_u32 s61, s61, 65536
    s_mul_i32 s12, s5, 80
    s_mul_i32 s13, s3, 61440
    s_add_u32 s13, s13, s12
    s_add_u32 s13, s13, 1280
    s_mov_b32 s15, 1280
    v_add_u32 v9, 0, v0
    v_mul_u32_u24 v10, 1639, v9
    v_lshrrev_b32 v10, 16, v10
    v_mul_u32_u24 v11, 40, v10
    v_sub_u32 v9, v9, v11
    v_cmp_gt_u32 vcc, 32, v9
    v_bfe_u32 v11, v9, 4, 1
    v_and_b32 v12, 1, v9
    v_cndmask_b32 v11, v12, v11, vcc
    v_bfe_u32 v12, v9, 2, 2
    v_bfe_u32 v13, v9, 1, 2
    v_cndmask_b32 v12, v13, v12, vcc
    v_and_b32 v13, 1, v13
    v_and_b32 v9, 3, v9
    v_add_u32 v9, v9, v13
    v_cndmask_b32 v9, 2, v9, vcc
    v_lshl_add_u32 v10, v10, 2, v12
    v_mul_u32_u24 v10, 3840, v10
    v_mad_u32_u24 v10, v11, s15, v10
    v_lshl_add_u32 v10, v9, 4, v10
    v_add_u32 v6, s13, v10
    v_add_u32 v9, 64, v0
    v_mul_u32_u24 v10, 1639, v9
    v_lshrrev_b32 v10, 16, v10
    v_mul_u32_u24 v11, 40, v10
    v_sub_u32 v9, v9, v11
    v_cmp_gt_u32 vcc, 32, v9
    v_bfe_u32 v11, v9, 4, 1
    v_and_b32 v12, 1, v9
    v_cndmask_b32 v11, v12, v11, vcc
    v_bfe_u32 v12, v9, 2, 2
    v_bfe_u32 v13, v9, 1, 2
    v_cndmask_b32 v12, v13, v12, vcc
    v_and_b32 v13, 1, v13
    v_and_b32 v9, 3, v9
    v_add_u32 v9, v9, v13
    v_cndmask_b32 v9, 2, v9, vcc
    v_lshl_add_u32 v10, v10, 2, v12
    v_mul_u32_u24 v10, 3840, v10
    v_mad_u32_u24 v10, v11, s15, v10
    v_lshl_add_u32 v10, v9, 4, v10
    v_add_u32 v7, s13, v10
    v_add_u32 v9, 128, v0
    v_mul_u32_u24 v10, 1639, v9
    v_lshrrev_b32 v10, 16, v10
    v_mul_u32_u24 v11, 40, v10
    v_sub_u32 v9, v9, v11
    v_cmp_gt_u32 vcc, 32, v9
    v_bfe_u32 v11, v9, 4, 1
    v_and_b32 v12, 1, v9
    v_cndmask_b32 v11, v12, v11, vcc
    v_bfe_u32 v12, v9, 2, 2
    v_bfe_u32 v13, v9, 1, 2
    v_cndmask_b32 v12, v13, v12, vcc
    v_and_b32 v13, 1, v13
    v_and_b32 v9, 3, v9
    v_add_u32 v9, v9, v13
    v_cndmask_b32 v9, 2, v9, vcc
    v_lshl_add_u32 v10, v10, 2, v12
    v_mul_u32_u24 v10, 3840, v10
    v_mad_u32_u24 v10, v11, s15, v10
    v_lshl_add_u32 v10, v9, 4, v10
    v_add_u32 v8, s13, v10
    s_waitcnt lgkmcnt(0)
    s_mov_b32 s26, 2621440
    s_mov_b32 s27, 0x20000
    s_mov_b32 s30, 2457600
    s_mov_b32 s31, 0x20000
    s_mov_b32 s34, 0x1100000
    s_mov_b32 s35, 0x20000
    s_cmp_ge_u32 s2, 16
    s_cbranch_scc1 L_noclr_1
    s_lshl2_add_u32 s12, s2, s3
    s_lshl_b32 s12, s12, 10
    v_mov_b32 v28, 0
    v_mov_b32 v29, 0
    v_mov_b32 v30, 0
    v_mov_b32 v31, 0
    buffer_store_dwordx4 v[28:31], v1, s[32:35], s12 offen sc1
L_noclr_1:
    s_lshl_b32 s66, s100, 7
    s_add_u32 m0, s60, 0
    s_nop 0
    buffer_load_dwordx4 v2, s[24:27], s66 offen lds
    s_mul_i32 s67, s100, 245760
    s_add_u32 s100, s100, 1
    s_cmp_eq_u32 s100, 10
    s_cselect_b32 s100, 0, s100
    s_add_u32 m0, s61, 0
    s_nop 0
    buffer_load_dwordx4 v6, s[28:31], s67 offen lds
    s_add_u32 m0, s60, 1024
    s_nop 0
    buffer_load_dwordx4 v3, s[24:27], s66 offen lds
    s_add_u32 m0, s61, 1024
    s_nop 0
    buffer_load_dwordx4 v7, s[28:31], s67 offen lds
    s_add_u32 m0, s60, 2048
    s_nop 0
    buffer_load_dwordx4 v4, s[24:27], s66 offen lds
    s_add_u32 m0, s61, 2048
    s_mov_b32 exec_hi, 0
    buffer_load_dwordx4 v8, s[28:31], s67 offen lds
    s_mov_b32 exec_hi, -1
    s_add_u32 m0, s60, 3072
    s_nop 0
    buffer_load_dwordx4 v5, s[24:27], s66 offen lds
    s_lshl_b32 s66, s100, 7
    s_add_u32 m0, s60, 16384
    s_nop 0
    buffer_load_dwordx4 v2, s[24:27], s66 offen lds
    s_mul_i32 s67, s100, 245760
    s_add_u32 s100, s100, 1
    s_cmp_eq_u32 s100, 10
    s_cselect_b32 s100, 0, s100
    s_add_u32 m0, s61, 10240
    s_nop 0
    buffer_load_dwordx4 v6, s[28:31], s67 offen lds
    s_add_u32 m0, s60, 17408
    s_nop 0
    buffer_load_dwordx4 v3, s[24:27], s66 offen lds
    s_add_u32 m0, s61, 11264
    s_nop 0
    buffer_load_dwordx4 v7, s[28:31], s67 offen lds
    s_add_u32 m0, s60, 18432
    s_nop 0
    buffer_load_dwordx4 v4, s[24:27], s66 offen lds
    s_add_u32 m0, s61, 12288
    s_mov_b32 exec_hi, 0
    buffer_load_dwordx4 v8, s[28:31], s67 offen lds
    s_mov_b32 exec_hi, -1
    s_add_u32 m0, s60, 19456
    s_nop 0
    buffer_load_dwordx4 v5, s[24:27], s66 offen lds
    s_mov_b32 s58, 256
    s_mov_b32 s59, 0x20000
    v_and_b32 v25, 31, v0
    v_lshrrev_b32 v26, 5, v0
    v_bfe_u32 v27, v0, 1, 3
    v_xor_b32 v9, v27, v26
    v_lshlrev_b32 v25, 7, v25
    v_add_u32 v10, s60, v25
    v_bfe_u32 v27, v0, 2, 2
    v_bfe_u32 v12, v0, 4, 1
    v_and_b32 v11, 3, v0
    v_lshl_add_u32 v12, v12, 2, v11
    v_lshrrev_b32 v25, 1, v12
    v_and_b32 v11, 1, v12
    v_lshlrev_b32 v12, 6, v27
    v_lshl_add_u32 v12, v11, 5, v12
    v_lshl_add_u32 v12, v25, 3, v12
    v_mul_u32_u24 v13, 1280, v26
    v_add_u32 v138, 66048, v13
    v_lshl_add_u32 v138, v27, 5, v138
    v_lshl_add_u32 v138, v11, 3, v138
    v_and_b32 v139, 1, v25
    v_lshl_add_u32 v141, v139, 4, v138
    v_add_u32 v13, v13, v12
    v_add_u32 v21, 65536, v13
    s_add_u32 s12, s3, 0
    s_and_b32 s12, s12, 3
    s_lshl_b32 s13, s12, 1
    s_mul_i32 s14, s12, 2560
    v_xor_b32 v13, s13, v9
    v_lshl_add_u32 v14, v13, 4, v10
    v_add_u32 v18, s14, v21
    v_add_u32 v138, s14, v141
    s_add_u32 s12, s3, 1
    s_and_b32 s12, s12, 3
    s_lshl_b32 s13, s12, 1
    s_mul_i32 s14, s12, 2560
    v_xor_b32 v13, s13, v9
    v_lshl_add_u32 v15, v13, 4, v10
    v_add_u32 v19, s14, v21
    v_add_u32 v139, s14, v141
    s_add_u32 s12, s3, 2
    s_and_b32 s12, s12, 3
    s_lshl_b32 s13, s12, 1
    s_mul_i32 s14, s12, 2560
    v_xor_b32 v13, s13, v9
    v_lshl_add_u32 v16, v13, 4, v10
    v_add_u32 v20, s14, v21
    v_add_u32 v140, s14, v141
    s_add_u32 s12, s3, 3
    s_and_b32 s12, s12, 3
    s_lshl_b32 s13, s12, 1
    s_mul_i32 s14, s12, 2560
    v_xor_b32 v13, s13, v9
    v_lshl_add_u32 v17, v13, 4, v10
    v_add_u32 v21, s14, v21
    v_add_u32 v141, s14, v141
    v_mov_b32 v136, 0x3f803f80
    v_mov_b32 v137, 0x3f803f80
    v_mul_u32_u24 v13, 640, v26
    v_add_u32 v149, 106752, v13
    v_lshl_add_u32 v149, v27, 4, v149
    v_lshl_add_u32 v149, v11, 3, v149
    v_add_u32 v13, v13, v12
    v_add_u32 v145, 106496, v13
    v_cmp_eq_u32 vcc, v26, v11
    v_mul_u32_u24 v9, 960, v26
    v_mul_u32_u24 v10, 40, v27
    v_lshl_add_u32 v10, v25, 3, v10
    v_add_u32 v11, v9, v10
    v_add_u32 v11, 157696, v11
    v_mov_b32 v12, 159360
    v_cndmask_b32 v156, v12, v11, vcc
    v_mul_u32_u24 v9, 160, v26
    v_add_u32 v11, v9, v10
    v_add_u32 v11, 158336, v11
    v_cndmask_b32 v157, v12, v11, vcc
    v_lshlrev_b32 v12, 7, v0
    s_mov_b32 s54, 25600
    s_mov_b32 s55, 0x20000
    s_mov_b32 s38, 1966080
    s_mov_b32 s39, 0x20000
    s_mov_b32 s42, 2621440
    s_mov_b32 s43, 0x20000
    s_lshr_b32 s12, s10, 1
    s_lshr_b32 s13, s11, 3
    s_lshl2_add_u32 s6, s12, s13
    s_bfe_u32 s7, s11, 0x10002
    s_and_b32 s12, s10, 1
    s_and_b32 s13, s11, 3
    s_lshl2_add_u32 s8, s12, s13
    s_mov_b32 s1, s4
    s_mov_b32 s9, s5
    s_lshl_b32 s12, s3, 8
    s_add_u32 s12, s12, s2
    s_mul_i32 s13, s12, 3277
    s_lshr_b32 s13, s13, 16
    s_mul_i32 s14, s13, 20
    s_sub_u32 s14, s12, s14
    s_sub_u32 s15, s12, 160
    s_mul_i32 s16, s15, 1366
    s_lshr_b32 s16, s16, 16
    s_mul_i32 s17, s16, 48
    s_sub_u32 s17, s15, s17
    s_mul_i32 s18, s12, 5120
    s_add_u32 s18, s18, 14680064
    s_mul_i32 s19, s15, 5120
    s_add_u32 s19, s19, 15728640
    s_mul_i32 s22, s14, 13108
    s_lshr_b32 s22, s22, 16
    s_lshl2_add_u32 s22, s13, s22
    s_add_u32 s22, s22, 384
    s_mul_i32 s23, s17, 5462
    s_lshr_b32 s23, s23, 16
    s_lshl2_add_u32 s23, s16, s23
    s_add_u32 s23, s23, 416
    s_mov_b64 s[96:97], s[44:45]
    s_cmp_lt_u32 s12, 160
    s_cselect_b32 s13, s13, s16
    s_cselect_b32 s14, s14, s17
    s_cselect_b32 s18, s18, s19
    s_cselect_b32 s22, s22, s23
    s_cselect_b32 s44, s44, s20
    s_cselect_b32 s45, s45, s21
    s_cselect_b32 s46, 1, 0
    s_cselect_b64 vcc, -1, 0
    s_mul_i32 s46, s46, -1146880
    s_add_u32 s46, s46, 1966080
    s_lshl_b32 s22, s22, 7
    s_mov_b32 s47, 0x20000
    s_mov_b32 s48, s32
    s_mov_b32 s49, s33
    s_mov_b32 s51, 0x20000
    s_cmp_lt_u32 s12, 544
    s_cselect_b32 s46, s46, 0
    s_cselect_b32 s50, 0x1100000, 0
    s_mov_b32 s0, s18
    s_mov_b32 s99, s22
    s_mul_i32 s98, s13, 160
    s_lshl_b32 s15, s14, 2
    s_lshl_b32 s16, s14, 5
    s_mov_b32 s18, 0x10201808
    v_lshrrev_b32 v26, 1, v0
    v_lshrrev_b32 v27, 4, v0
    v_add_u32 v27, s15, v27
    v_mul_u32_u24 v28, 13108, v27
    v_lshrrev_b32 v28, 16, v28
    v_mul_u32_u24 v29, 5, v28
    v_sub_u32 v27, v27, v29
    v_lshlrev_b32 v27, 3, v27
    v_subrev_u32 v29, 8, v27
    v_bfe_u32 v29, s18, v29, 8
    v_cmp_eq_u32 s[22:23], 0, v27
    v_mul_u32_u24 v28, 40, v28
    v_and_b32 v27, 7, v26
    v_cndmask_b32 v29, v29, 0, s[22:23]
    v_add3_u32 v28, v28, v29, v27
    v_and_b32 v27, 19, v26
    v_bfe_u32 v29, v26, 2, 1
    v_lshl_add_u32 v27, v29, 3, v27
    v_bfe_u32 v29, v26, 3, 1
    v_lshl_add_u32 v27, v29, 2, v27
    v_add_u32 v27, s16, v27
    v_cndmask_b32 v27, v27, v28, vcc
    v_mul_u32_u24 v27, 1280, v27
    v_and_b32 v25, 1, v0
    v_lshl_add_u32 v199, v25, 4, v27
    v_accvgpr_write_b32 a232, v199
    v_mov_b32 v28, 0
    v_mov_b32 v29, 0
    v_mov_b32 v30, 0
    v_mov_b32 v31, 0
    s_lshl_b32 s12, s3, 9
    s_add_u32 s12, s12, 159360
    v_add_u32 v25, s12, v1
    s_mov_b32 exec_hi, 0
    ds_write_b128 v25, v[28:31]
    s_mov_b32 exec_hi, -1
    s_mul_i32 s12, s5, 80
    s_mul_i32 s13, s3, 122880
    s_add_u32 s13, s13, s12
    v_add_u32 v25, 0, v0
    v_mul_u32_u24 v26, 3277, v25
    v_lshrrev_b32 v26, 16, v26
    v_mul_u32_u24 v27, 20, v26
    v_sub_u32 v25, v25, v27
    v_cmp_gt_u32 vcc, 16, v25
    v_lshrrev_b32 v27, 2, v25
    v_and_b32 v28, 3, v25
    v_cndmask_b32 v27, v28, v27, vcc
    v_bfe_u32 v29, v25, 1, 1
    v_add_u32 v28, v28, v29
    v_cndmask_b32 v28, 2, v28, vcc
    v_lshl_add_u32 v26, v26, 2, v27
    v_mul_u32_u24 v26, 3840, v26
    v_lshl_add_u32 v26, v28, 4, v26
    v_add_u32 v9, s13, v26
    v_add_u32 v25, 64, v0
    v_mul_u32_u24 v26, 3277, v25
    v_lshrrev_b32 v26, 16, v26
    v_mul_u32_u24 v27, 20, v26
    v_sub_u32 v25, v25, v27
    v_cmp_gt_u32 vcc, 16, v25
    v_lshrrev_b32 v27, 2, v25
    v_and_b32 v28, 3, v25
    v_cndmask_b32 v27, v28, v27, vcc
    v_bfe_u32 v29, v25, 1, 1
    v_add_u32 v28, v28, v29
    v_cndmask_b32 v28, 2, v28, vcc
    v_lshl_add_u32 v26, v26, 2, v27
    v_mul_u32_u24 v26, 3840, v26
    v_lshl_add_u32 v26, v28, 4, v26
    v_add_u32 v10, s13, v26
    v_add_u32 v25, 128, v0
    v_mul_u32_u24 v26, 3277, v25
    v_lshrrev_b32 v26, 16, v26
    v_mul_u32_u24 v27, 20, v26
    v_sub_u32 v25, v25, v27
    v_cmp_gt_u32 vcc, 16, v25
    v_lshrrev_b32 v27, 2, v25
    v_and_b32 v28, 3, v25
    v_cndmask_b32 v27, v28, v27, vcc
    v_bfe_u32 v29, v25, 1, 1
    v_add_u32 v28, v28, v29
    v_cndmask_b32 v28, 2, v28, vcc
    v_lshl_add_u32 v26, v26, 2, v27
    v_mul_u32_u24 v26, 3840, v26
    v_lshl_add_u32 v26, v28, 4, v26
    v_add_u32 v11, s13, v26
    s_add_u32 s12, s3, 0
    s_and_b32 s12, s12, 3
    s_mul_i32 s14, s12, 1280
    v_add_u32 v142, s14, v145
    v_add_u32 v146, s14, v149
    s_add_u32 s12, s3, 1
    s_and_b32 s12, s12, 3
    s_mul_i32 s14, s12, 1280
    v_add_u32 v143, s14, v145
    v_add_u32 v147, s14, v149
    s_add_u32 s12, s3, 2
    s_and_b32 s12, s12, 3
    s_mul_i32 s14, s12, 1280
    v_add_u32 v144, s14, v145
    v_add_u32 v148, s14, v149
    s_add_u32 s12, s3, 3
    s_and_b32 s12, s12, 3
    s_mul_i32 s14, s12, 1280
    v_add_u32 v145, s14, v145
    v_add_u32 v149, s14, v149
    v_lshrrev_b32 v25, 5, v0
    v_and_b32 v29, 31, v0
    s_lshl_b32 s12, s3, 11
    v_mul_u32_u24 v25, 24576, v25
    v_lshl_add_u32 v25, v29, 6, v25
    v_add_u32 v25, s12, v25
    v_bfe_u32 v29, v0, 1, 2
    v_lshl_add_u32 v224, v29, 4, v25
    v_xor_b32 v30, 1, v29
    v_lshl_add_u32 v225, v30, 4, v25
    v_xor_b32 v30, 2, v29
    v_lshl_add_u32 v226, v30, 4, v25
    v_lshrrev_b32 v25, 5, v0
    v_bfe_u32 v30, v0, 2, 2
    v_lshl_add_u32 v25, v25, 3, v30
    v_lshlrev_b32 v25, 6, v25
    v_and_b32 v31, 1, v0
    v_lshl_add_u32 v25, v31, 3, v25
    v_bfe_u32 v31, v0, 4, 1
    v_bfe_u32 v26, v0, 1, 1
    v_lshl_add_u32 v31, v31, 1, v26
    v_lshrrev_b32 v30, 1, v30
    v_min_u32 v31, 2, v31
    v_xor_b32 v31, v31, v30
    s_lshr_b32 s12, s3, 1
    s_mul_i32 s12, s12, 24576
    s_and_b32 s13, s3, 1
    s_lshl_b32 s13, s13, 13
    s_add_u32 s13, s13, s12
    s_add_u32 s12, s12, 16384
    v_lshl_add_u32 v26, v31, 4, v25
    v_xor_b32 v31, 2, v31
    v_lshl_add_u32 v27, v31, 4, v25
    v_add_u32 v27, 256, v27
    v_add_u32 v229, s12, v26
    v_add_u32 v230, s12, v27
    v_add_u32 v227, s13, v26
    v_add_u32 v228, s13, v27
    v_and_b32 v25, 31, v0
    v_lshrrev_b32 v26, 5, v0
    v_mul_u32_u24 v27, 384, v26
    v_lshl_add_u32 v162, v25, 4, v27
    v_lshlrev_b32 v163, 3, v25
    v_lshlrev_b32 v27, 4, v25
    v_add_u32 v153, 161408, v27
    s_lshl_b32 s12, s3, 9
    v_add_u32 v152, s12, v153
    v_lshlrev_b32 v27, 2, v25
    v_add_u32 v154, 163456, v27
    v_lshlrev_b32 v27, 4, v26
    v_add_u32 v155, 163456, v27
    s_mul_i32 s12, s9, 192
    s_mul_i32 s13, s3, 49152
    s_add_u32 s13, s13, s12
    v_add_u32 v25, 0, v0
    v_mul_u32_u24 v26, 5462, v25
    v_lshrrev_b32 v26, 16, v26
    v_mul_u32_u24 v27, 12, v26
    v_sub_u32 v25, v25, v27
    v_mul_u32_u24 v26, 3072, v26
    v_lshl_add_u32 v26, v25, 4, v26
    v_add_u32 v22, s13, v26
    v_add_u32 v25, 64, v0
    v_mul_u32_u24 v26, 5462, v25
    v_lshrrev_b32 v26, 16, v26
    v_mul_u32_u24 v27, 12, v26
    v_sub_u32 v25, v25, v27
    v_mul_u32_u24 v26, 3072, v26
    v_lshl_add_u32 v26, v25, 4, v26
    v_add_u32 v23, s13, v26
    v_add_u32 v25, 128, v0
    v_mul_u32_u24 v26, 5462, v25
    v_lshrrev_b32 v26, 16, v26
    v_mul_u32_u24 v27, 12, v26
    v_sub_u32 v25, v25, v27
    v_mul_u32_u24 v26, 3072, v26
    v_lshl_add_u32 v26, v25, 4, v26
    v_add_u32 v24, s13, v26
    s_lshl_b32 s66, s100, 7
    s_add_u32 m0, s60, 32768
    s_nop 0
    buffer_load_dwordx4 v2, s[24:27], s66 offen lds
    s_mul_i32 s67, s100, 245760
    s_add_u32 s100, s100, 1
    s_cmp_eq_u32 s100, 10
    s_cselect_b32 s100, 0, s100
    s_add_u32 m0, s61, 20480
    s_nop 0
    buffer_load_dwordx4 v6, s[28:31], s67 offen lds
    s_add_u32 m0, s60, 33792
    s_nop 0
    buffer_load_dwordx4 v3, s[24:27], s66 offen lds
    s_waitcnt vmcnt(10)
    s_barrier
    ds_read_b128 a[0:3], v14 offset:0
    ds_read_b64_tr_b16 v[100:101], v18 offset:0
    ds_read_b64_tr_b16 v[102:103], v18 offset:640
    ds_read_b64_tr_b16 v[104:105], v18 offset:256
    ds_read_b64_tr_b16 v[106:107], v18 offset:896
    ds_read_b64_tr_b16 v[108:109], v138 offset:0
    ds_read_b64_tr_b16 v[110:111], v138 offset:640
    ds_read_b128 a[4:7], v15 offset:0
    ds_read_b64_tr_b16 v[112:113], v19 offset:0
    ds_read_b64_tr_b16 v[114:115], v19 offset:640
    ds_read_b64_tr_b16 v[116:117], v19 offset:256
    ds_read_b64_tr_b16 v[118:119], v19 offset:896
    ds_read_b64_tr_b16 v[120:121], v139 offset:0
    ds_read_b64_tr_b16 v[122:123], v139 offset:640
    s_cmp_ge_u32 s2, 16
    s_cbranch_scc1 L_noflag_2
    s_lshl2_add_u32 s62, s2, s3
    s_lshl_b32 s62, s62, 2
    v_mov_b32 v161, 1
    s_mov_b64 exec, 1
    buffer_store_dword v161, v1, s[56:59], s62 offen sc1
    s_mov_b64 exec, -1
L_noflag_2:
    s_waitcnt lgkmcnt(7)
    v_mfma_f32_32x32x16_bf16 v[32:47], v[100:103], a[0:3], 0
    s_add_u32 m0, s61, 21504
    s_nop 0
    buffer_load_dwordx4 v7, s[28:31], s67 offen lds
    ds_read_b128 a[8:11], v16 offset:0
    s_add_u32 m0, s60, 34816
    s_nop 0
    buffer_load_dwordx4 v4, s[24:27], s66 offen lds
    ds_read_b64_tr_b16 v[124:125], v20 offset:0
    ds_read_b64_tr_b16 v[126:127], v20 offset:640
    v_mfma_f32_32x32x16_bf16 v[48:63], v[104:107], a[0:3], 0
    s_add_u32 m0, s61, 22528
    s_mov_b32 exec_hi, 0
    buffer_load_dwordx4 v8, s[28:31], s67 offen lds
    s_mov_b32 exec_hi, -1
    ds_read_b64_tr_b16 v[128:129], v20 offset:256
    ds_read_b64_tr_b16 v[130:131], v20 offset:896
    ds_read_b64_tr_b16 v[132:133], v140 offset:0
    v_mfma_f32_32x32x16_bf16 v[64:79], v[108:111], a[0:3], 0
    s_add_u32 m0, s60, 35840
    s_nop 0
    buffer_load_dwordx4 v5, s[24:27], s66 offen lds
    ds_read_b64_tr_b16 v[134:135], v140 offset:640
    v_mfma_f32_4x4x4_16b_bf16 v[80:83], v[136:137], a[0:1], 0
    v_mfma_f32_4x4x4_16b_bf16 v[84:87], a[0:1], a[0:1], 0
    v_mfma_f32_4x4x4_16b_bf16 v[88:91], v[136:137], v[100:101], 0
    v_mfma_f32_4x4x4_16b_bf16 v[80:83], v[136:137], a[2:3], v[80:83]
    v_mfma_f32_4x4x4_16b_bf16 v[84:87], a[2:3], a[2:3], v[84:87]
    v_mfma_f32_4x4x4_16b_bf16 v[92:95], v[136:137], v[104:105], 0
    v_mfma_f32_4x4x4_16b_bf16 v[96:99], v[136:137], v[108:109], 0
    v_mfma_f32_4x4x4_16b_bf16 v[88:91], v[136:137], v[102:103], v[88:91]
    v_mfma_f32_4x4x4_16b_bf16 v[92:95], v[136:137], v[106:107], v[92:95]
    v_mfma_f32_4x4x4_16b_bf16 v[96:99], v[136:137], v[110:111], v[96:99]
    s_waitcnt lgkmcnt(7)
    v_mfma_f32_32x32x16_bf16 v[32:47], v[112:115], a[4:7], v[32:47]
    ds_read_b128 a[12:15], v17 offset:0
    ds_read_b64_tr_b16 v[100:101], v21 offset:0
    ds_read_b64_tr_b16 v[102:103], v21 offset:640
    v_mfma_f32_32x32x16_bf16 v[48:63], v[116:119], a[4:7], v[48:63]
    s_lshl_b32 s66, s100, 7
    s_add_u32 m0, s60, 49152
    s_nop 0
    buffer_load_dwordx4 v2, s[24:27], s66 offen lds
    ds_read_b64_tr_b16 v[104:105], v21 offset:256
    ds_read_b64_tr_b16 v[106:107], v21 offset:896
    ds_read_b64_tr_b16 v[108:109], v141 offset:0
    v_mfma_f32_32x32x16_bf16 v[64:79], v[120:123], a[4:7], v[64:79]
    ds_read_b64_tr_b16 v[110:111], v141 offset:640
    v_mfma_f32_4x4x4_16b_bf16 v[80:83], v[136:137], a[4:5], v[80:83]
    v_mfma_f32_4x4x4_16b_bf16 v[84:87], a[4:5], a[4:5], v[84:87]
    s_nop 0
    v_mfma_f32_4x4x4_16b_bf16 v[80:83], v[136:137], a[6:7], v[80:83]
    v_mfma_f32_4x4x4_16b_bf16 v[84:87], a[6:7], a[6:7], v[84:87]
    s_waitcnt vmcnt(8)
    s_waitcnt lgkmcnt(0)
    s_barrier
    v_mfma_f32_32x32x16_bf16 v[32:47], v[124:127], a[8:11], v[32:47]
    s_mul_i32 s67, s100, 245760
    s_add_u32 s100, s100, 1
    s_cmp_eq_u32 s100, 10
    s_cselect_b32 s100, 0, s100
    s_add_u32 m0, s61, 30720
    s_nop 0
    buffer_load_dwordx4 v6, s[28:31], s67 offen lds
    ds_read_b128 a[16:19], v14 offset:16384
    ds_read_b64_tr_b16 v[112:113], v18 offset:10240
    ds_read_b64_tr_b16 v[114:115], v18 offset:10880
    v_mfma_f32_32x32x16_bf16 v[48:63], v[128:131], a[8:11], v[48:63]
    ds_read_b64_tr_b16 v[116:117], v18 offset:10496
    ds_read_b64_tr_b16 v[118:119], v18 offset:11136
    ds_read_b64_tr_b16 v[120:121], v138 offset:10240
    v_mfma_f32_32x32x16_bf16 v[64:79], v[132:135], a[8:11], v[64:79]
    s_add_u32 m0, s60, 50176
    s_nop 0
    buffer_load_dwordx4 v3, s[24:27], s66 offen lds
    ds_read_b64_tr_b16 v[122:123], v138 offset:10880
    v_mfma_f32_4x4x4_16b_bf16 v[80:83], v[136:137], a[8:9], v[80:83]
    v_mfma_f32_4x4x4_16b_bf16 v[84:87], a[8:9], a[8:9], v[84:87]
    s_nop 0
    v_mfma_f32_4x4x4_16b_bf16 v[80:83], v[136:137], a[10:11], v[80:83]
    v_mfma_f32_4x4x4_16b_bf16 v[84:87], a[10:11], a[10:11], v[84:87]
    v_mfma_f32_32x32x16_bf16 v[32:47], v[100:103], a[12:15], v[32:47]
    ds_read_b128 a[20:23], v15 offset:16384
    ds_read_b64_tr_b16 v[124:125], v19 offset:10240
    ds_read_b64_tr_b16 v[126:127], v19 offset:10880
    v_mfma_f32_32x32x16_bf16 v[48:63], v[104:107], a[12:15], v[48:63]
    s_add_u32 m0, s61, 31744
    s_nop 0
    buffer_load_dwordx4 v7, s[28:31], s67 offen lds
    ds_read_b64_tr_b16 v[128:129], v19 offset:10496
    ds_read_b64_tr_b16 v[130:131], v19 offset:11136
    ds_read_b64_tr_b16 v[132:133], v139 offset:10240
    v_mfma_f32_32x32x16_bf16 v[64:79], v[108:111], a[12:15], v[64:79]
    ds_read_b64_tr_b16 v[134:135], v139 offset:10880
    v_mfma_f32_4x4x4_16b_bf16 v[80:83], v[136:137], a[12:13], v[80:83]
    v_mfma_f32_4x4x4_16b_bf16 v[84:87], a[12:13], a[12:13], v[84:87]
    s_nop 0
    v_mfma_f32_4x4x4_16b_bf16 v[80:83], v[136:137], a[14:15], v[80:83]
    v_mfma_f32_4x4x4_16b_bf16 v[84:87], a[14:15], a[14:15], v[84:87]
    s_waitcnt lgkmcnt(7)
    v_mfma_f32_32x32x16_bf16 v[32:47], v[112:115], a[16:19], v[32:47]
    s_add_u32 m0, s60, 51200
    s_nop 0
    buffer_load_dwordx4 v4, s[24:27], s66 offen lds
    ds_read_b128 a[24:27], v16 offset:16384
    ds_read_b64_tr_b16 v[100:101], v20 offset:10240
    ds_read_b64_tr_b16 v[102:103], v20 offset:10880
    v_mfma_f32_32x32x16_bf16 v[48:63], v[116:119], a[16:19], v[48:63]
    ds_read_b64_tr_b16 v[104:105], v20 offset:10496
    ds_read_b64_tr_b16 v[106:107], v20 offset:11136
    ds_read_b64_tr_b16 v[108:109], v140 offset:10240
    s_add_u32 m0, s61, 32768
    s_mov_b32 exec_hi, 0
    buffer_load_dwordx4 v8, s[28:31], s67 offen lds
    s_mov_b32 exec_hi, -1
    v_mfma_f32_32x32x16_bf16 v[64:79], v[120:123], a[16:19], v[64:79]
    ds_read_b64_tr_b16 v[110:111], v140 offset:10880
    v_mfma_f32_4x4x4_16b_bf16 v[80:83], v[136:137], a[16:17], v[80:83]
    v_mfma_f32_4x4x4_16b_bf16 v[84:87], a[16:17], a[16:17], v[84:87]
    v_mfma_f32_4x4x4_16b_bf16 v[88:91], v[136:137], v[112:113], v[88:91]
    v_mfma_f32_4x4x4_16b_bf16 v[80:83], v[136:137], a[18:19], v[80:83]
    v_mfma_f32_4x4x4_16b_bf16 v[84:87], a[18:19], a[18:19], v[84:87]
    v_mfma_f32_4x4x4_16b_bf16 v[92:95], v[136:137], v[116:117], v[92:95]
    v_mfma_f32_4x4x4_16b_bf16 v[96:99], v[136:137], v[120:121], v[96:99]
    v_mfma_f32_4x4x4_16b_bf16 v[88:91], v[136:137], v[114:115], v[88:91]
    v_mfma_f32_4x4x4_16b_bf16 v[92:95], v[136:137], v[118:119], v[92:95]
    v_mfma_f32_4x4x4_16b_bf16 v[96:99], v[136:137], v[122:123], v[96:99]
    s_waitcnt lgkmcnt(7)
    v_mfma_f32_32x32x16_bf16 v[32:47], v[124:127], a[20:23], v[32:47]
    ds_read_b128 a[28:31], v17 offset:16384
    ds_read_b64_tr_b16 v[112:113], v21 offset:10240
    s_add_u32 m0, s60, 52224
    s_nop 0
    buffer_load_dwordx4 v5, s[24:27], s66 offen lds
    ds_read_b64_tr_b16 v[114:115], v21 offset:10880
    v_mfma_f32_32x32x16_bf16 v[48:63], v[128:131], a[20:23], v[48:63]
    ds_read_b64_tr_b16 v[116:117], v21 offset:10496
    ds_read_b64_tr_b16 v[118:119], v21 offset:11136
    ds_read_b64_tr_b16 v[120:121], v141 offset:10240
    v_mfma_f32_32x32x16_bf16 v[64:79], v[132:135], a[20:23], v[64:79]
    s_lshl_b32 s66, s100, 7
    s_add_u32 m0, s60, 0
    s_nop 0
    buffer_load_dwordx4 v2, s[24:27], s66 offen lds
    ds_read_b64_tr_b16 v[122:123], v141 offset:10880
    v_mfma_f32_4x4x4_16b_bf16 v[80:83], v[136:137], a[20:21], v[80:83]
    v_mfma_f32_4x4x4_16b_bf16 v[84:87], a[20:21], a[20:21], v[84:87]
    s_nop 0
    v_mfma_f32_4x4x4_16b_bf16 v[80:83], v[136:137], a[22:23], v[80:83]
    v_mfma_f32_4x4x4_16b_bf16 v[84:87], a[22:23], a[22:23], v[84:87]
    s_waitcnt vmcnt(8)
    s_waitcnt lgkmcnt(0)
    s_barrier
    v_mfma_f32_32x32x16_bf16 v[32:47], v[100:103], a[24:27], v[32:47]
    ds_read_b128 a[32:35], v14 offset:32768
    ds_read_b64_tr_b16 v[124:125], v18 offset:20480
    ds_read_b64_tr_b16 v[126:127], v18 offset:21120
    v_mfma_f32_32x32x16_bf16 v[48:63], v[104:107], a[24:27], v[48:63]
    s_mul_i32 s67, s100, 245760
    s_add_u32 s100, s100, 1
    s_cmp_eq_u32 s100, 10
    s_cselect_b32 s100, 0, s100
    s_add_u32 m0, s61, 0
    s_nop 0
    buffer_load_dwordx4 v6, s[28:31], s67 offen lds
    ds_read_b64_tr_b16 v[128:129], v18 offset:20736
    ds_read_b64_tr_b16 v[130:131], v18 offset:21376
    ds_read_b64_tr_b16 v[132:133], v138 offset:20480
    v_mfma_f32_32x32x16_bf16 v[64:79], v[108:111], a[24:27], v[64:79]
    ds_read_b64_tr_b16 v[134:135], v138 offset:21120
    v_mfma_f32_4x4x4_16b_bf16 v[80:83], v[136:137], a[24:25], v[80:83]
    v_mfma_f32_4x4x4_16b_bf16 v[84:87], a[24:25], a[24:25], v[84:87]
    s_nop 0
    v_mfma_f32_4x4x4_16b_bf16 v[80:83], v[136:137], a[26:27], v[80:83]
    v_mfma_f32_4x4x4_16b_bf16 v[84:87], a[26:27], a[26:27], v[84:87]
    v_mfma_f32_32x32x16_bf16 v[32:47], v[112:115], a[28:31], v[32:47]
    s_add_u32 m0, s60, 1024
    s_nop 0
    buffer_load_dwordx4 v3, s[24:27], s66 offen lds
    ds_read_b128 a[36:39], v15 offset:32768
    ds_read_b64_tr_b16 v[100:101], v19 offset:20480
    ds_read_b64_tr_b16 v[102:103], v19 offset:21120
    v_mfma_f32_32x32x16_bf16 v[48:63], v[116:119], a[28:31], v[48:63]
    ds_read_b64_tr_b16 v[104:105], v19 offset:20736
    ds_read_b64_tr_b16 v[106:107], v19 offset:21376
    ds_read_b64_tr_b16 v[108:109], v139 offset:20480
    v_mfma_f32_32x32x16_bf16 v[64:79], v[120:123], a[28:31], v[64:79]
    s_add_u32 m0, s61, 1024
    s_nop 0
    buffer_load_dwordx4 v7, s[28:31], s67 offen lds
    ds_read_b64_tr_b16 v[110:111], v139 offset:21120
    v_mfma_f32_4x4x4_16b_bf16 v[80:83], v[136:137], a[28:29], v[80:83]
    v_mfma_f32_4x4x4_16b_bf16 v[84:87], a[28:29], a[28:29], v[84:87]
    s_nop 0
    v_mfma_f32_4x4x4_16b_bf16 v[80:83], v[136:137], a[30:31], v[80:83]
    v_mfma_f32_4x4x4_16b_bf16 v[84:87], a[30:31], a[30:31], v[84:87]
    s_waitcnt lgkmcnt(7)
    v_mfma_f32_32x32x16_bf16 v[32:47], v[124:127], a[32:35], v[32:47]
    ds_read_b128 a[40:43], v16 offset:32768
    ds_read_b64_tr_b16 v[112:113], v20 offset:20480
    ds_read_b64_tr_b16 v[114:115], v20 offset:21120
    v_mfma_f32_32x32x16_bf16 v[48:63], v[128:131], a[32:35], v[48:63]
    s_add_u32 m0, s60, 2048
    s_nop 0
    buffer_load_dwordx4 v4, s[24:27], s66 offen lds
    ds_read_b64_tr_b16 v[116:117], v20 offset:20736
    ds_read_b64_tr_b16 v[118:119], v20 offset:21376
    ds_read_b64_tr_b16 v[120:121], v140 offset:20480
    v_mfma_f32_32x32x16_bf16 v[64:79], v[132:135], a[32:35], v[64:79]
    ds_read_b64_tr_b16 v[122:123], v140 offset:21120
    v_mfma_f32_4x4x4_16b_bf16 v[80:83], v[136:137], a[32:33], v[80:83]
    v_mfma_f32_4x4x4_16b_bf16 v[84:87], a[32:33], a[32:33], v[84:87]
    v_mfma_f32_4x4x4_16b_bf16 v[88:91], v[136:137], v[124:125], v[88:91]
    v_mfma_f32_4x4x4_16b_bf16 v[80:83], v[136:137], a[34:35], v[80:83]
    v_mfma_f32_4x4x4_16b_bf16 v[84:87], a[34:35], a[34:35], v[84:87]
    v_mfma_f32_4x4x4_16b_bf16 v[92:95], v[136:137], v[128:129], v[92:95]
    v_mfma_f32_4x4x4_16b_bf16 v[96:99], v[136:137], v[132:133], v[96:99]
    v_mfma_f32_4x4x4_16b_bf16 v[88:91], v[136:137], v[126:127], v[88:91]
    v_mfma_f32_4x4x4_16b_bf16 v[92:95], v[136:137], v[130:131], v[92:95]
    v_mfma_f32_4x4x4_16b_bf16 v[96:99], v[136:137], v[134:135], v[96:99]
    s_waitcnt lgkmcnt(7)
    v_mfma_f32_32x32x16_bf16 v[32:47], v[100:103], a[36:39], v[32:47]
    s_add_u32 m0, s61, 2048
    s_mov_b32 exec_hi, 0
    buffer_load_dwordx4 v8, s[28:31], s67 offen lds
    s_mov_b32 exec_hi, -1
    ds_read_b128 a[44:47], v17 offset:32768
    ds_read_b64_tr_b16 v[124:125], v21 offset:20480
    ds_read_b64_tr_b16 v[126:127], v21 offset:21120
    v_mfma_f32_32x32x16_bf16 v[48:63], v[104:107], a[36:39], v[48:63]
    ds_read_b64_tr_b16 v[128:129], v21 offset:20736
    ds_read_b64_tr_b16 v[130:131], v21 offset:21376
    ds_read_b64_tr_b16 v[132:133], v141 offset:20480
    v_mfma_f32_32x32x16_bf16 v[64:79], v[108:111], a[36:39], v[64:79]
    s_add_u32 m0, s60, 3072
    s_nop 0
    buffer_load_dwordx4 v5, s[24:27], s66 offen lds
    ds_read_b64_tr_b16 v[134:135], v141 offset:21120
    v_mfma_f32_4x4x4_16b_bf16 v[80:83], v[136:137], a[36:37], v[80:83]
    v_mfma_f32_4x4x4_16b_bf16 v[84:87], a[36:37], a[36:37], v[84:87]
    s_nop 0
    v_mfma_f32_4x4x4_16b_bf16 v[80:83], v[136:137], a[38:39], v[80:83]
    v_mfma_f32_4x4x4_16b_bf16 v[84:87], a[38:39], a[38:39], v[84:87]
    s_waitcnt vmcnt(7)
    s_waitcnt lgkmcnt(0)
    s_barrier
    v_mfma_f32_32x32x16_bf16 v[32:47], v[112:115], a[40:43], v[32:47]
    ds_read_b128 a[48:51], v14 offset:49152
    ds_read_b64_tr_b16 v[100:101], v18 offset:30720
    ds_read_b64_tr_b16 v[102:103], v18 offset:31360
    v_mfma_f32_32x32x16_bf16 v[48:63], v[116:119], a[40:43], v[48:63]
    s_mul_i32 s62, s5, 1600
    s_mul_i32 s63, s3, 400
    s_add_u32 s62, s62, s63
    s_add_u32 m0, s63, 157696
    s_mov_b64 exec, 0x1ffffff
    buffer_load_dwordx4 v1, s[52:55], s62 offen lds
    s_mov_b64 exec, -1
    ds_read_b64_tr_b16 v[104:105], v18 offset:30976
    ds_read_b64_tr_b16 v[106:107], v18 offset:31616
    ds_read_b64_tr_b16 v[108:109], v138 offset:30720
    v_mfma_f32_32x32x16_bf16 v[64:79], v[120:123], a[40:43], v[64:79]
    ds_read_b64_tr_b16 v[110:111], v138 offset:31360
    v_mfma_f32_4x4x4_16b_bf16 v[80:83], v[136:137], a[40:41], v[80:83]
    v_mfma_f32_4x4x4_16b_bf16 v[84:87], a[40:41], a[40:41], v[84:87]
    s_nop 0
    v_mfma_f32_4x4x4_16b_bf16 v[80:83], v[136:137], a[42:43], v[80:83]
    v_mfma_f32_4x4x4_16b_bf16 v[84:87], a[42:43], a[42:43], v[84:87]
    v_mfma_f32_32x32x16_bf16 v[32:47], v[124:127], a[44:47], v[32:47]
    s_lshl_b32 s66, s100, 7
    s_add_u32 m0, s60, 16384
    s_nop 0
    buffer_load_dwordx4 v2, s[24:27], s66 offen lds
    ds_read_b128 a[52:55], v15 offset:49152
    ds_read_b64_tr_b16 v[112:113], v19 offset:30720
    ds_read_b64_tr_b16 v[114:115], v19 offset:31360
    v_mfma_f32_32x32x16_bf16 v[48:63], v[128:131], a[44:47], v[48:63]
    ds_read_b64_tr_b16 v[116:117], v19 offset:30976
    ds_read_b64_tr_b16 v[118:119], v19 offset:31616
    ds_read_b64_tr_b16 v[120:121], v139 offset:30720
    s_mul_i32 s67, s100, 245760
    s_add_u32 s100, s100, 1
    s_cmp_eq_u32 s100, 10
    s_cselect_b32 s100, 0, s100
    s_add_u32 m0, s61, 10240
    s_nop 0
    buffer_load_dwordx4 v6, s[28:31], s67 offen lds
    v_mfma_f32_32x32x16_bf16 v[64:79], v[132:135], a[44:47], v[64:79]
    ds_read_b64_tr_b16 v[122:123], v139 offset:31360
    v_mfma_f32_4x4x4_16b_bf16 v[80:83], v[136:137], a[44:45], v[80:83]
    v_mfma_f32_4x4x4_16b_bf16 v[84:87], a[44:45], a[44:45], v[84:87]
    s_nop 0
    v_mfma_f32_4x4x4_16b_bf16 v[80:83], v[136:137], a[46:47], v[80:83]
    v_mfma_f32_4x4x4_16b_bf16 v[84:87], a[46:47], a[46:47], v[84:87]
    s_waitcnt lgkmcnt(7)
    v_mfma_f32_32x32x16_bf16 v[32:47], v[100:103], a[48:51], v[32:47]
    ds_read_b128 a[56:59], v16 offset:49152
    ds_read_b64_tr_b16 v[124:125], v20 offset:30720
    s_add_u32 m0, s60, 17408
    s_nop 0
    buffer_load_dwordx4 v3, s[24:27], s66 offen lds
    ds_read_b64_tr_b16 v[126:127], v20 offset:31360
    v_mfma_f32_32x32x16_bf16 v[48:63], v[104:107], a[48:51], v[48:63]
    ds_read_b64_tr_b16 v[128:129], v20 offset:30976
    ds_read_b64_tr_b16 v[130:131], v20 offset:31616
    ds_read_b64_tr_b16 v[132:133], v140 offset:30720
    v_mfma_f32_32x32x16_bf16 v[64:79], v[108:111], a[48:51], v[64:79]
    s_add_u32 m0, s61, 11264
    s_nop 0
    buffer_load_dwordx4 v7, s[28:31], s67 offen lds
    ds_read_b64_tr_b16 v[134:135], v140 offset:31360
    v_mfma_f32_4x4x4_16b_bf16 v[80:83], v[136:137], a[48:49], v[80:83]
    v_mfma_f32_4x4x4_16b_bf16 v[84:87], a[48:49], a[48:49], v[84:87]
    v_mfma_f32_4x4x4_16b_bf16 v[88:91], v[136:137], v[100:101], v[88:91]
    v_mfma_f32_4x4x4_16b_bf16 v[80:83], v[136:137], a[50:51], v[80:83]
    v_mfma_f32_4x4x4_16b_bf16 v[84:87], a[50:51], a[50:51], v[84:87]
    v_mfma_f32_4x4x4_16b_bf16 v[92:95], v[136:137], v[104:105], v[92:95]
    v_mfma_f32_4x4x4_16b_bf16 v[96:99], v[136:137], v[108:109], v[96:99]
    v_mfma_f32_4x4x4_16b_bf16 v[88:91], v[136:137], v[102:103], v[88:91]
    v_mfma_f32_4x4x4_16b_bf16 v[92:95], v[136:137], v[106:107], v[92:95]
    v_mfma_f32_4x4x4_16b_bf16 v[96:99], v[136:137], v[110:111], v[96:99]
    s_waitcnt lgkmcnt(7)
    v_mfma_f32_32x32x16_bf16 v[32:47], v[112:115], a[52:55], v[32:47]
    ds_read_b128 a[60:63], v17 offset:49152
    ds_read_b64_tr_b16 v[100:101], v21 offset:30720
    ds_read_b64_tr_b16 v[102:103], v21 offset:31360
    v_mfma_f32_32x32x16_bf16 v[48:63], v[116:119], a[52:55], v[48:63]
    s_add_u32 m0, s60, 18432
    s_nop 0
    buffer_load_dwordx4 v4, s[24:27], s66 offen lds
    ds_read_b64_tr_b16 v[104:105], v21 offset:30976
    ds_read_b64_tr_b16 v[106:107], v21 offset:31616
    ds_read_b64_tr_b16 v[108:109], v141 offset:30720
    v_mfma_f32_32x32x16_bf16 v[64:79], v[120:123], a[52:55], v[64:79]
    ds_read_b64_tr_b16 v[110:111], v141 offset:31360
    v_mfma_f32_4x4x4_16b_bf16 v[80:83], v[136:137], a[52:53], v[80:83]
    v_mfma_f32_4x4x4_16b_bf16 v[84:87], a[52:53], a[52:53], v[84:87]
    s_nop 0
    v_mfma_f32_4x4x4_16b_bf16 v[80:83], v[136:137], a[54:55], v[80:83]
    v_mfma_f32_4x4x4_16b_bf16 v[84:87], a[54:55], a[54:55], v[84:87]
    s_waitcnt vmcnt(6)
    s_waitcnt lgkmcnt(0)
    s_barrier
    v_lshrrev_b32 v161, 2, v1
    buffer_load_dword v161, v161, s[56:59], 0 offen sc1
    v_mfma_f32_32x32x16_bf16 v[32:47], v[124:127], a[56:59], v[32:47]
    s_add_u32 m0, s61, 12288
    s_mov_b32 exec_hi, 0
    buffer_load_dwordx4 v8, s[28:31], s67 offen lds
    s_mov_b32 exec_hi, -1
    ds_read_b128 a[64:67], v14 offset:0
    ds_read_b64_tr_b16 v[112:113], v18 offset:0
    ds_read_b64_tr_b16 v[114:115], v18 offset:640
    v_mfma_f32_32x32x16_bf16 v[48:63], v[128:131], a[56:59], v[48:63]
    ds_read_b64_tr_b16 v[116:117], v18 offset:256
    ds_read_b64_tr_b16 v[118:119], v18 offset:896
    ds_read_b64_tr_b16 v[120:121], v138 offset:0
    v_mfma_f32_32x32x16_bf16 v[64:79], v[132:135], a[56:59], v[64:79]
    s_add_u32 m0, s60, 19456
    s_nop 0
    buffer_load_dwordx4 v5, s[24:27], s66 offen lds
    ds_read_b64_tr_b16 v[122:123], v138 offset:640
    v_mfma_f32_4x4x4_16b_bf16 v[80:83], v[136:137], a[56:57], v[80:83]
    v_mfma_f32_4x4x4_16b_bf16 v[84:87], a[56:57], a[56:57], v[84:87]
    s_nop 0
    v_mfma_f32_4x4x4_16b_bf16 v[80:83], v[136:137], a[58:59], v[80:83]
    v_mfma_f32_4x4x4_16b_bf16 v[84:87], a[58:59], a[58:59], v[84:87]
    v_mfma_f32_32x32x16_bf16 v[32:47], v[100:103], a[60:63], v[32:47]
    ds_read_b128 a[68:71], v15 offset:0
    ds_read_b64_tr_b16 v[124:125], v19 offset:0
    ds_read_b64_tr_b16 v[126:127], v19 offset:640
    v_mfma_f32_32x32x16_bf16 v[48:63], v[104:107], a[60:63], v[48:63]
    s_lshl_b32 s66, s100, 7
    s_add_u32 m0, s60, 32768
    s_nop 0
    buffer_load_dwordx4 v2, s[24:27], s66 offen lds
    ds_read_b64_tr_b16 v[128:129], v19 offset:256
    ds_read_b64_tr_b16 v[130:131], v19 offset:896
    ds_read_b64_tr_b16 v[132:133], v139 offset:0
    v_mfma_f32_32x32x16_bf16 v[64:79], v[108:111], a[60:63], v[64:79]
    ds_read_b64_tr_b16 v[134:135], v139 offset:640
    v_mfma_f32_4x4x4_16b_bf16 v[80:83], v[136:137], a[60:61], v[80:83]
    v_mfma_f32_4x4x4_16b_bf16 v[84:87], a[60:61], a[60:61], v[84:87]
    s_nop 0
    v_mfma_f32_4x4x4_16b_bf16 v[80:83], v[136:137], a[62:63], v[80:83]
    v_mfma_f32_4x4x4_16b_bf16 v[84:87], a[62:63], a[62:63], v[84:87]
    s_waitcnt lgkmcnt(7)
    v_mfma_f32_32x32x16_bf16 v[32:47], v[112:115], a[64:67], v[32:47]
    s_mul_i32 s67, s100, 245760
    s_add_u32 s100, s100, 1
    s_cmp_eq_u32 s100, 10
    s_cselect_b32 s100, 0, s100
    s_add_u32 m0, s61, 20480
    s_nop 0
    buffer_load_dwordx4 v6, s[28:31], s67 offen lds
    ds_read_b128 a[72:75], v16 offset:0
    ds_read_b64_tr_b16 v[100:101], v20 offset:0
    ds_read_b64_tr_b16 v[102:103], v20 offset:640
    v_mfma_f32_32x32x16_bf16 v[48:63], v[116:119], a[64:67], v[48:63]
    ds_read_b64_tr_b16 v[104:105], v20 offset:256
    ds_read_b64_tr_b16 v[106:107], v20 offset:896
    ds_read_b64_tr_b16 v[108:109], v140 offset:0
    s_add_u32 m0, s60, 33792
    s_nop 0
    buffer_load_dwordx4 v3, s[24:27], s66 offen lds
    v_mfma_f32_32x32x16_bf16 v[64:79], v[120:123], a[64:67], v[64:79]
    ds_read_b64_tr_b16 v[110:111], v140 offset:640
    v_mfma_f32_4x4x4_16b_bf16 v[80:83], v[136:137], a[64:65], v[80:83]
    v_mfma_f32_4x4x4_16b_bf16 v[84:87], a[64:65], a[64:65], v[84:87]
    v_mfma_f32_4x4x4_16b_bf16 v[88:91], v[136:137], v[112:113], v[88:91]
    v_mfma_f32_4x4x4_16b_bf16 v[80:83], v[136:137], a[66:67], v[80:83]
    v_mfma_f32_4x4x4_16b_bf16 v[84:87], a[66:67], a[66:67], v[84:87]
    v_mfma_f32_4x4x4_16b_bf16 v[92:95], v[136:137], v[116:117], v[92:95]
    v_mfma_f32_4x4x4_16b_bf16 v[96:99], v[136:137], v[120:121], v[96:99]
    v_mfma_f32_4x4x4_16b_bf16 v[88:91], v[136:137], v[114:115], v[88:91]
    v_mfma_f32_4x4x4_16b_bf16 v[92:95], v[136:137], v[118:119], v[92:95]
    v_mfma_f32_4x4x4_16b_bf16 v[96:99], v[136:137], v[122:123], v[96:99]
    s_waitcnt lgkmcnt(7)
    v_mfma_f32_32x32x16_bf16 v[32:47], v[124:127], a[68:71], v[32:47]
    ds_read_b128 a[76:79], v17 offset:0
    ds_read_b64_tr_b16 v[112:113], v21 offset:0
    s_add_u32 m0, s61, 21504
    s_nop 0
    buffer_load_dwordx4 v7, s[28:31], s67 offen lds
    ds_read_b64_tr_b16 v[114:115], v21 offset:640
    v_mfma_f32_32x32x16_bf16 v[48:63], v[128:131], a[68:71], v[48:63]
    ds_read_b64_tr_b16 v[116:117], v21 offset:256
    ds_read_b64_tr_b16 v[118:119], v21 offset:896
    ds_read_b64_tr_b16 v[120:121], v141 offset:0
    v_mfma_f32_32x32x16_bf16 v[64:79], v[132:135], a[68:71], v[64:79]
    s_add_u32 m0, s60, 34816
    s_nop 0
    buffer_load_dwordx4 v4, s[24:27], s66 offen lds
    ds_read_b64_tr_b16 v[122:123], v141 offset:640
    v_mfma_f32_4x4x4_16b_bf16 v[80:83], v[136:137], a[68:69], v[80:83]
    v_mfma_f32_4x4x4_16b_bf16 v[84:87], a[68:69], a[68:69], v[84:87]
    s_nop 0
    v_mfma_f32_4x4x4_16b_bf16 v[80:83], v[136:137], a[70:71], v[80:83]
    v_mfma_f32_4x4x4_16b_bf16 v[84:87], a[70:71], a[70:71], v[84:87]
    s_waitcnt vmcnt(5)
    s_waitcnt lgkmcnt(0)
    s_barrier
    s_mov_b32 s62, 0
L_gate_4:
    v_cmp_eq_u32 s[64:65], 0, v161
    s_add_u32 s62, s62, 1
    s_nop 0
    s_cmp_eq_u64 s[64:65], 0
    s_cbranch_scc1 L_gated_5
    s_cmp_ge_u32 s62, 40000
    s_cbranch_scc1 L_gated_5
    v_lshrrev_b32 v161, 2, v1
    buffer_load_dword v161, v161, s[56:59], 0 offen sc1
    s_waitcnt vmcnt(0)
    s_branch L_gate_4
L_gated_5:
    v_mfma_f32_32x32x16_bf16 v[32:47], v[100:103], a[72:75], v[32:47]
    ds_read_b64_tr_b16 v[232:233], v156 offset:0
    ds_read_b64_tr_b16 v[234:235], v156 offset:160
    ds_read_b128 a[80:83], v14 offset:16384
    ds_read_b64_tr_b16 v[124:125], v18 offset:10240
    ds_read_b64_tr_b16 v[126:127], v18 offset:10880
    v_mfma_f32_32x32x16_bf16 v[48:63], v[104:107], a[72:75], v[48:63]
    s_add_u32 m0, s61, 22528
    s_mov_b32 exec_hi, 0
    buffer_load_dwordx4 v8, s[28:31], s67 offen lds
    s_mov_b32 exec_hi, -1
    ds_read_b64_tr_b16 v[236:237], v156 offset:320
    ds_read_b64_tr_b16 v[238:239], v156 offset:480
    ds_read_b64_tr_b16 v[128:129], v18 offset:10496
    ds_read_b64_tr_b16 v[130:131], v18 offset:11136
    ds_read_b64_tr_b16 v[132:133], v138 offset:10240
    v_mfma_f32_32x32x16_bf16 v[64:79], v[108:111], a[72:75], v[64:79]
    ds_read_b64_tr_b16 v[240:241], v157 offset:0
    v_mov_b32 v242, 0
    ds_read_b64_tr_b16 v[134:135], v138 offset:10880
    v_mfma_f32_4x4x4_16b_bf16 v[80:83], v[136:137], a[72:73], v[80:83]
    v_mfma_f32_4x4x4_16b_bf16 v[84:87], a[72:73], a[72:73], v[84:87]
    s_nop 0
    v_mfma_f32_4x4x4_16b_bf16 v[80:83], v[136:137], a[74:75], v[80:83]
    v_mfma_f32_4x4x4_16b_bf16 v[84:87], a[74:75], a[74:75], v[84:87]
    v_mfma_f32_32x32x16_bf16 v[32:47], v[112:115], a[76:79], v[32:47]
    s_add_u32 m0, s60, 35840
    s_nop 0
    buffer_load_dwordx4 v5, s[24:27], s66 offen lds
    v_mov_b32 v243, 0
    ds_read_b64_tr_b16 v[244:245], v156 offset:32
    ds_read_b128 a[84:87], v15 offset:16384
    ds_read_b64_tr_b16 v[100:101], v19 offset:10240
    ds_read_b64_tr_b16 v[102:103], v19 offset:10880
    v_mfma_f32_32x32x16_bf16 v[48:63], v[116:119], a[76:79], v[48:63]
    ds_read_b64_tr_b16 v[246:247], v156 offset:192
    ds_read_b64_tr_b16 v[248:249], v156 offset:352
    ds_read_b64_tr_b16 v[104:105], v19 offset:10496
    ds_read_b64_tr_b16 v[106:107], v19 offset:11136
    ds_read_b64_tr_b16 v[108:109], v139 offset:10240
    v_mfma_f32_32x32x16_bf16 v[64:79], v[120:123], a[76:79], v[64:79]
    s_lshl_b32 s66, s100, 7
    s_add_u32 m0, s60, 49152
    s_nop 0
    buffer_load_dwordx4 v2, s[24:27], s66 offen lds
    ds_read_b64_tr_b16 v[250:251], v156 offset:512
    ds_read_b64_tr_b16 v[252:253], v157 offset:32
    ds_read_b64_tr_b16 v[110:111], v139 offset:10880
    v_mfma_f32_4x4x4_16b_bf16 v[80:83], v[136:137], a[76:77], v[80:83]
    v_mfma_f32_4x4x4_16b_bf16 v[84:87], a[76:77], a[76:77], v[84:87]
    s_nop 0
    v_mfma_f32_4x4x4_16b_bf16 v[80:83], v[136:137], a[78:79], v[80:83]
    v_mfma_f32_4x4x4_16b_bf16 v[84:87], a[78:79], a[78:79], v[84:87]
    s_waitcnt lgkmcnt(12)
    v_mfma_f32_32x32x16_bf16 v[32:47], v[124:127], a[80:83], v[32:47]
    v_mov_b32 v254, 0
    v_mov_b32 v255, 0
    ds_read_b128 a[88:91], v16 offset:16384
    ds_read_b64_tr_b16 v[112:113], v20 offset:10240
    ds_read_b64_tr_b16 v[114:115], v20 offset:10880
    v_mfma_f32_32x32x16_bf16 v[48:63], v[128:131], a[80:83], v[48:63]
    s_mul_i32 s67, s100, 245760
    s_add_u32 s100, s100, 1
    s_cmp_eq_u32 s100, 10
    s_cselect_b32 s100, 0, s100
    s_add_u32 m0, s61, 30720
    s_nop 0
    buffer_load_dwordx4 v6, s[28:31], s67 offen lds
    ds_read_b64_tr_b16 v[116:117], v20 offset:10496
    ds_read_b64_tr_b16 v[118:119], v20 offset:11136
    ds_read_b64_tr_b16 v[120:121], v140 offset:10240
    v_mfma_f32_32x32x16_bf16 v[64:79], v[132:135], a[80:83], v[64:79]
    ds_read_b64_tr_b16 v[122:123], v140 offset:10880
    v_mfma_f32_4x4x4_16b_bf16 v[80:83], v[136:137], a[80:81], v[80:83]
    v_mfma_f32_4x4x4_16b_bf16 v[84:87], a[80:81], a[80:81], v[84:87]
    v_mfma_f32_4x4x4_16b_bf16 v[88:91], v[136:137], v[124:125], v[88:91]
    v_mfma_f32_4x4x4_16b_bf16 v[80:83], v[136:137], a[82:83], v[80:83]
    v_mfma_f32_4x4x4_16b_bf16 v[84:87], a[82:83], a[82:83], v[84:87]
    v_mfma_f32_4x4x4_16b_bf16 v[92:95], v[136:137], v[128:129], v[92:95]
    v_mfma_f32_4x4x4_16b_bf16 v[96:99], v[136:137], v[132:133], v[96:99]
    v_mfma_f32_4x4x4_16b_bf16 v[88:91], v[136:137], v[126:127], v[88:91]
    v_mfma_f32_4x4x4_16b_bf16 v[92:95], v[136:137], v[130:131], v[92:95]
    v_mfma_f32_4x4x4_16b_bf16 v[96:99], v[136:137], v[134:135], v[96:99]
    s_waitcnt lgkmcnt(7)
    v_mfma_f32_32x32x16_bf16 v[32:47], v[100:103], a[84:87], v[32:47]
    s_add_u32 m0, s60, 50176
    s_nop 0
    buffer_load_dwordx4 v3, s[24:27], s66 offen lds
    ds_read_b128 a[92:95], v17 offset:16384
    ds_read_b64_tr_b16 v[124:125], v21 offset:10240
    ds_read_b64_tr_b16 v[126:127], v21 offset:10880
    v_mfma_f32_32x32x16_bf16 v[48:63], v[104:107], a[84:87], v[48:63]
    ds_read_b64_tr_b16 v[128:129], v21 offset:10496
    ds_read_b64_tr_b16 v[130:131], v21 offset:11136
    ds_read_b64_tr_b16 v[132:133], v141 offset:10240
    v_mfma_f32_32x32x16_bf16 v[64:79], v[108:111], a[84:87], v[64:79]
    s_add_u32 m0, s61, 31744
    s_nop 0
    buffer_load_dwordx4 v7, s[28:31], s67 offen lds
    ds_read_b64_tr_b16 v[134:135], v141 offset:10880
    v_mfma_f32_4x4x4_16b_bf16 v[80:83], v[136:137], a[84:85], v[80:83]
    v_mfma_f32_4x4x4_16b_bf16 v[84:87], a[84:85], a[84:85], v[84:87]
    s_nop 0
    v_mfma_f32_4x4x4_16b_bf16 v[80:83], v[136:137], a[86:87], v[80:83]
    v_mfma_f32_4x4x4_16b_bf16 v[84:87], a[86:87], a[86:87], v[84:87]
    s_waitcnt vmcnt(4)
    s_waitcnt lgkmcnt(0)
    s_barrier
    v_mfma_f32_32x32x16_bf16 v[32:47], v[112:115], a[88:91], v[32:47]
    ds_read_b128 a[96:99], v14 offset:32768
    ds_read_b64_tr_b16 v[100:101], v18 offset:20480
    ds_read_b64_tr_b16 v[102:103], v18 offset:21120
    v_mfma_f32_32x32x16_bf16 v[48:63], v[116:119], a[88:91], v[48:63]
    s_add_u32 m0, s60, 51200
    s_nop 0
    buffer_load_dwordx4 v4, s[24:27], s66 offen lds
    ds_read_b64_tr_b16 v[104:105], v18 offset:20736
    ds_read_b64_tr_b16 v[106:107], v18 offset:21376
    ds_read_b64_tr_b16 v[108:109], v138 offset:20480
    v_mfma_f32_32x32x16_bf16 v[64:79], v[120:123], a[88:91], v[64:79]
    ds_read_b64_tr_b16 v[110:111], v138 offset:21120
    v_mfma_f32_4x4x4_16b_bf16 v[80:83], v[136:137], a[88:89], v[80:83]
    v_mfma_f32_4x4x4_16b_bf16 v[84:87], a[88:89], a[88:89], v[84:87]
    s_nop 0
    v_mfma_f32_4x4x4_16b_bf16 v[80:83], v[136:137], a[90:91], v[80:83]
    v_mfma_f32_4x4x4_16b_bf16 v[84:87], a[90:91], a[90:91], v[84:87]
    v_mfma_f32_32x32x16_bf16 v[32:47], v[124:127], a[92:95], v[32:47]
    s_add_u32 m0, s61, 32768
    s_mov_b32 exec_hi, 0
    buffer_load_dwordx4 v8, s[28:31], s67 offen lds
    s_mov_b32 exec_hi, -1
    ds_read_b128 a[100:103], v15 offset:32768
    ds_read_b64_tr_b16 v[112:113], v19 offset:20480
    ds_read_b64_tr_b16 v[114:115], v19 offset:21120
    v_mfma_f32_32x32x16_bf16 v[48:63], v[128:131], a[92:95], v[48:63]
    ds_read_b64_tr_b16 v[116:117], v19 offset:20736
    ds_read_b64_tr_b16 v[118:119], v19 offset:21376
    ds_read_b64_tr_b16 v[120:121], v139 offset:20480
    s_add_u32 m0, s60, 52224
    s_nop 0
    buffer_load_dwordx4 v5, s[24:27], s66 offen lds
    v_mfma_f32_32x32x16_bf16 v[64:79], v[132:135], a[92:95], v[64:79]
    ds_read_b64_tr_b16 v[122:123], v139 offset:21120
    v_mfma_f32_4x4x4_16b_bf16 v[80:83], v[136:137], a[92:93], v[80:83]
    v_mfma_f32_4x4x4_16b_bf16 v[84:87], a[92:93], a[92:93], v[84:87]
    s_nop 0
    v_mfma_f32_4x4x4_16b_bf16 v[80:83], v[136:137], a[94:95], v[80:83]
    v_mfma_f32_4x4x4_16b_bf16 v[84:87], a[94:95], a[94:95], v[84:87]
    s_waitcnt lgkmcnt(7)
    v_mfma_f32_32x32x16_bf16 v[32:47], v[100:103], a[96:99], v[32:47]
    ds_read_b128 a[104:107], v16 offset:32768
    ds_read_b64_tr_b16 v[124:125], v20 offset:20480
    s_lshl_b32 s66, s100, 7
    s_add_u32 m0, s60, 0
    s_nop 0
    buffer_load_dwordx4 v2, s[24:27], s66 offen lds
    ds_read_b64_tr_b16 v[126:127], v20 offset:21120
    v_mfma_f32_32x32x16_bf16 v[48:63], v[104:107], a[96:99], v[48:63]
    ds_read_b64_tr_b16 v[128:129], v20 offset:20736
    ds_read_b64_tr_b16 v[130:131], v20 offset:21376
    ds_read_b64_tr_b16 v[132:133], v140 offset:20480
    v_mfma_f32_32x32x16_bf16 v[64:79], v[108:111], a[96:99], v[64:79]
    s_mul_i32 s67, s100, 245760
    s_add_u32 s100, s100, 1
    s_cmp_eq_u32 s100, 10
    s_cselect_b32 s100, 0, s100
    s_add_u32 m0, s61, 0
    s_nop 0
    buffer_load_dwordx4 v6, s[28:31], s67 offen lds
    ds_read_b64_tr_b16 v[134:135], v140 offset:21120
    v_mfma_f32_4x4x4_16b_bf16 v[80:83], v[136:137], a[96:97], v[80:83]
    v_mfma_f32_4x4x4_16b_bf16 v[84:87], a[96:97], a[96:97], v[84:87]
    v_mfma_f32_4x4x4_16b_bf16 v[88:91], v[136:137], v[100:101], v[88:91]
    v_mfma_f32_4x4x4_16b_bf16 v[80:83], v[136:137], a[98:99], v[80:83]
    v_mfma_f32_4x4x4_16b_bf16 v[84:87], a[98:99], a[98:99], v[84:87]
    v_mfma_f32_4x4x4_16b_bf16 v[92:95], v[136:137], v[104:105], v[92:95]
    v_mfma_f32_4x4x4_16b_bf16 v[96:99], v[136:137], v[108:109], v[96:99]
    v_mfma_f32_4x4x4_16b_bf16 v[88:91], v[136:137], v[102:103], v[88:91]
    v_mfma_f32_4x4x4_16b_bf16 v[92:95], v[136:137], v[106:107], v[92:95]
    v_mfma_f32_4x4x4_16b_bf16 v[96:99], v[136:137], v[110:111], v[96:99]
    s_waitcnt lgkmcnt(7)
    v_mfma_f32_32x32x16_bf16 v[32:47], v[112:115], a[100:103], v[32:47]
    ds_read_b128 a[108:111], v17 offset:32768
    ds_read_b64_tr_b16 v[100:101], v21 offset:20480
    ds_read_b64_tr_b16 v[102:103], v21 offset:21120
    v_mfma_f32_32x32x16_bf16 v[48:63], v[116:119], a[100:103], v[48:63]
    s_add_u32 m0, s60, 1024
    s_nop 0
    buffer_load_dwordx4 v3, s[24:27], s66 offen lds
    ds_read_b64_tr_b16 v[104:105], v21 offset:20736
    ds_read_b64_tr_b16 v[106:107], v21 offset:21376
    ds_read_b64_tr_b16 v[108:109], v141 offset:20480
    v_mfma_f32_32x32x16_bf16 v[64:79], v[120:123], a[100:103], v[64:79]
    ds_read_b64_tr_b16 v[110:111], v141 offset:21120
    v_mfma_f32_4x4x4_16b_bf16 v[80:83], v[136:137], a[100:101], v[80:83]
    v_mfma_f32_4x4x4_16b_bf16 v[84:87], a[100:101], a[100:101], v[84:87]
    s_nop 0
    v_mfma_f32_4x4x4_16b_bf16 v[80:83], v[136:137], a[102:103], v[80:83]
    v_mfma_f32_4x4x4_16b_bf16 v[84:87], a[102:103], a[102:103], v[84:87]
    s_waitcnt vmcnt(3)
    s_waitcnt lgkmcnt(0)
    s_barrier
    v_mfma_f32_32x32x16_bf16 v[32:47], v[124:127], a[104:107], v[32:47]
    s_add_u32 m0, s61, 1024
    s_nop 0
    buffer_load_dwordx4 v7, s[28:31], s67 offen lds
    ds_read_b128 a[112:115], v14 offset:49152
    ds_read_b64_tr_b16 v[112:113], v18 offset:30720
    ds_read_b64_tr_b16 v[114:115], v18 offset:31360
    v_mfma_f32_32x32x16_bf16 v[48:63], v[128:131], a[104:107], v[48:63]
    ds_read_b64_tr_b16 v[116:117], v18 offset:30976
    ds_read_b64_tr_b16 v[118:119], v18 offset:31616
    ds_read_b64_tr_b16 v[120:121], v138 offset:30720
    v_mfma_f32_32x32x16_bf16 v[64:79], v[132:135], a[104:107], v[64:79]
    s_add_u32 m0, s60, 2048
    s_nop 0
    buffer_load_dwordx4 v4, s[24:27], s66 offen lds
    ds_read_b64_tr_b16 v[122:123], v138 offset:31360
    v_mfma_f32_4x4x4_16b_bf16 v[80:83], v[136:137], a[104:105], v[80:83]
    v_mfma_f32_4x4x4_16b_bf16 v[84:87], a[104:105], a[104:105], v[84:87]
    s_nop 0
    v_mfma_f32_4x4x4_16b_bf16 v[80:83], v[136:137], a[106:107], v[80:83]
    v_mfma_f32_4x4x4_16b_bf16 v[84:87], a[106:107], a[106:107], v[84:87]
    v_mfma_f32_32x32x16_bf16 v[32:47], v[100:103], a[108:111], v[32:47]
    ds_read_b128 a[116:119], v15 offset:49152
    ds_read_b64_tr_b16 v[124:125], v19 offset:30720
    ds_read_b64_tr_b16 v[126:127], v19 offset:31360
    v_mfma_f32_32x32x16_bf16 v[48:63], v[104:107], a[108:111], v[48:63]
    s_add_u32 m0, s61, 2048
    s_mov_b32 exec_hi, 0
    buffer_load_dwordx4 v8, s[28:31], s67 offen lds
    s_mov_b32 exec_hi, -1
    ds_read_b64_tr_b16 v[128:129], v19 offset:30976
    ds_read_b64_tr_b16 v[130:131], v19 offset:31616
    ds_read_b64_tr_b16 v[132:133], v139 offset:30720
    v_mfma_f32_32x32x16_bf16 v[64:79], v[108:111], a[108:111], v[64:79]
    ds_read_b64_tr_b16 v[134:135], v139 offset:31360
    v_mfma_f32_4x4x4_16b_bf16 v[80:83], v[136:137], a[108:109], v[80:83]
    v_mfma_f32_4x4x4_16b_bf16 v[84:87], a[108:109], a[108:109], v[84:87]
    s_nop 0
    v_mfma_f32_4x4x4_16b_bf16 v[80:83], v[136:137], a[110:111], v[80:83]
    v_mfma_f32_4x4x4_16b_bf16 v[84:87], a[110:111], a[110:111], v[84:87]
    s_waitcnt lgkmcnt(7)
    v_mfma_f32_32x32x16_bf16 v[32:47], v[112:115], a[112:115], v[32:47]
    s_add_u32 m0, s60, 3072
    s_nop 0
    buffer_load_dwordx4 v5, s[24:27], s66 offen lds
    ds_read_b128 a[120:123], v16 offset:49152
    ds_read_b64_tr_b16 v[100:101], v20 offset:30720
    ds_read_b64_tr_b16 v[102:103], v20 offset:31360
    v_mfma_f32_32x32x16_bf16 v[48:63], v[116:119], a[112:115], v[48:63]
    ds_read_b64_tr_b16 v[104:105], v20 offset:30976
    ds_read_b64_tr_b16 v[106:107], v20 offset:31616
    ds_read_b64_tr_b16 v[108:109], v140 offset:30720
    v_mfma_f32_32x32x16_bf16 v[64:79], v[120:123], a[112:115], v[64:79]
    s_lshl2_add_u32 s62, s2, s3
    s_mul_i32 s62, s62, 3840
    s_mov_b64 exec, 0x3ff
    buffer_load_dword v13, v12, s[28:31], s62 offen offset:0
    s_mov_b64 exec, -1
    ds_read_b64_tr_b16 v[110:111], v140 offset:31360
    v_mfma_f32_4x4x4_16b_bf16 v[80:83], v[136:137], a[112:113], v[80:83]
    v_mfma_f32_4x4x4_16b_bf16 v[84:87], a[112:113], a[112:113], v[84:87]
    v_mfma_f32_4x4x4_16b_bf16 v[88:91], v[136:137], v[112:113], v[88:91]
    v_mfma_f32_4x4x4_16b_bf16 v[80:83], v[136:137], a[114:115], v[80:83]
    v_mfma_f32_4x4x4_16b_bf16 v[84:87], a[114:115], a[114:115], v[84:87]
    v_mfma_f32_4x4x4_16b_bf16 v[92:95], v[136:137], v[116:117], v[92:95]
    v_mfma_f32_4x4x4_16b_bf16 v[96:99], v[136:137], v[120:121], v[96:99]
    v_mfma_f32_4x4x4_16b_bf16 v[88:91], v[136:137], v[114:115], v[88:91]
    v_mfma_f32_4x4x4_16b_bf16 v[92:95], v[136:137], v[118:119], v[92:95]
    v_mfma_f32_4x4x4_16b_bf16 v[96:99], v[136:137], v[122:123], v[96:99]
    s_waitcnt lgkmcnt(7)
    v_mfma_f32_32x32x16_bf16 v[32:47], v[124:127], a[116:119], v[32:47]
    ds_read_b128 a[124:127], v17 offset:49152
    ds_read_b64_tr_b16 v[112:113], v21 offset:30720
    ds_read_b64_tr_b16 v[114:115], v21 offset:31360
    v_mfma_f32_32x32x16_bf16 v[48:63], v[128:131], a[116:119], v[48:63]
    s_lshl_b32 s66, s100, 7
    s_add_u32 m0, s60, 16384
    s_nop 0
    buffer_load_dwordx4 v2, s[24:27], s66 offen lds
    ds_read_b64_tr_b16 v[116:117], v21 offset:30976
    ds_read_b64_tr_b16 v[118:119], v21 offset:31616
    ds_read_b64_tr_b16 v[120:121], v141 offset:30720
    v_mfma_f32_32x32x16_bf16 v[64:79], v[132:135], a[116:119], v[64:79]
    ds_read_b64_tr_b16 v[122:123], v141 offset:31360
    v_mfma_f32_4x4x4_16b_bf16 v[80:83], v[136:137], a[116:117], v[80:83]
    v_mfma_f32_4x4x4_16b_bf16 v[84:87], a[116:117], a[116:117], v[84:87]
    s_nop 0
    v_mfma_f32_4x4x4_16b_bf16 v[80:83], v[136:137], a[118:119], v[80:83]
    v_mfma_f32_4x4x4_16b_bf16 v[84:87], a[118:119], a[118:119], v[84:87]
    s_waitcnt vmcnt(2)
    s_waitcnt lgkmcnt(0)
    s_barrier
    v_mfma_f32_32x32x16_bf16 v[32:47], v[100:103], a[120:123], v[32:47]
    s_mul_i32 s67, s100, 245760
    s_add_u32 s100, s100, 1
    s_cmp_eq_u32 s100, 10
    s_cselect_b32 s100, 0, s100
    s_add_u32 m0, s61, 10240
    s_nop 0
    buffer_load_dwordx4 v6, s[28:31], s67 offen lds
    ds_read_b128 a[128:131], v14 offset:0
    ds_read_b64_tr_b16 v[124:125], v18 offset:0
    ds_read_b64_tr_b16 v[126:127], v18 offset:640
    v_mfma_f32_32x32x16_bf16 v[48:63], v[104:107], a[120:123], v[48:63]
    ds_read_b64_tr_b16 v[128:129], v18 offset:256
    ds_read_b64_tr_b16 v[130:131], v18 offset:896
    s_add_u32 m0, s60, 17408
    s_nop 0
    buffer_load_dwordx4 v3, s[24:27], s66 offen lds
    ds_read_b64_tr_b16 v[132:133], v138 offset:0
    v_mfma_f32_32x32x16_bf16 v[64:79], v[108:111], a[120:123], v[64:79]
    ds_read_b64_tr_b16 v[134:135], v138 offset:640
    v_mfma_f32_4x4x4_16b_bf16 v[80:83], v[136:137], a[120:121], v[80:83]
    v_mfma_f32_4x4x4_16b_bf16 v[84:87], a[120:121], a[120:121], v[84:87]
    s_nop 0
    v_mfma_f32_4x4x4_16b_bf16 v[80:83], v[136:137], a[122:123], v[80:83]
    v_mfma_f32_4x4x4_16b_bf16 v[84:87], a[122:123], a[122:123], v[84:87]
    v_mfma_f32_32x32x16_bf16 v[32:47], v[112:115], a[124:127], v[32:47]
    ds_read_b128 a[132:135], v15 offset:0
    ds_read_b64_tr_b16 v[100:101], v19 offset:0
    s_add_u32 m0, s61, 11264
    s_nop 0
    buffer_load_dwordx4 v7, s[28:31], s67 offen lds
    ds_read_b64_tr_b16 v[102:103], v19 offset:640
    v_mfma_f32_32x32x16_bf16 v[48:63], v[116:119], a[124:127], v[48:63]
    ds_read_b64_tr_b16 v[104:105], v19 offset:256
    ds_read_b64_tr_b16 v[106:107], v19 offset:896
    ds_read_b64_tr_b16 v[108:109], v139 offset:0
    v_mfma_f32_32x32x16_bf16 v[64:79], v[120:123], a[124:127], v[64:79]
    s_add_u32 m0, s60, 18432
    s_nop 0
    buffer_load_dwordx4 v4, s[24:27], s66 offen lds
    ds_read_b64_tr_b16 v[110:111], v139 offset:640
    v_mfma_f32_4x4x4_16b_bf16 v[80:83], v[136:137], a[124:125], v[80:83]
    v_mfma_f32_4x4x4_16b_bf16 v[84:87], a[124:125], a[124:125], v[84:87]
    s_nop 0
    v_mfma_f32_4x4x4_16b_bf16 v[80:83], v[136:137], a[126:127], v[80:83]
    v_mfma_f32_4x4x4_16b_bf16 v[84:87], a[126:127], a[126:127], v[84:87]
    s_waitcnt lgkmcnt(7)
    v_mfma_f32_32x32x16_bf16 v[32:47], v[124:127], a[128:131], v[32:47]
    ds_read_b128 a[136:139], v16 offset:0
    ds_read_b64_tr_b16 v[112:113], v20 offset:0
    ds_read_b64_tr_b16 v[114:115], v20 offset:640
    v_mfma_f32_32x32x16_bf16 v[48:63], v[128:131], a[128:131], v[48:63]
    s_add_u32 m0, s61, 12288
    s_mov_b32 exec_hi, 0
    buffer_load_dwordx4 v8, s[28:31], s67 offen lds
    s_mov_b32 exec_hi, -1
    ds_read_b64_tr_b16 v[116:117], v20 offset:256
    ds_read_b64_tr_b16 v[118:119], v20 offset:896
    ds_read_b64_tr_b16 v[120:121], v140 offset:0
    v_mfma_f32_32x32x16_bf16 v[64:79], v[132:135], a[128:131], v[64:79]
    ds_read_b64_tr_b16 v[122:123], v140 offset:640
    v_mfma_f32_4x4x4_16b_bf16 v[80:83], v[136:137], a[128:129], v[80:83]
    v_mfma_f32_4x4x4_16b_bf16 v[84:87], a[128:129], a[128:129], v[84:87]
    v_mfma_f32_4x4x4_16b_bf16 v[88:91], v[136:137], v[124:125], v[88:91]
    v_mfma_f32_4x4x4_16b_bf16 v[80:83], v[136:137], a[130:131], v[80:83]
    v_mfma_f32_4x4x4_16b_bf16 v[84:87], a[130:131], a[130:131], v[84:87]
    v_mfma_f32_4x4x4_16b_bf16 v[92:95], v[136:137], v[128:129], v[92:95]
    v_mfma_f32_4x4x4_16b_bf16 v[96:99], v[136:137], v[132:133], v[96:99]
    v_mfma_f32_4x4x4_16b_bf16 v[88:91], v[136:137], v[126:127], v[88:91]
    v_mfma_f32_4x4x4_16b_bf16 v[92:95], v[136:137], v[130:131], v[92:95]
    v_mfma_f32_4x4x4_16b_bf16 v[96:99], v[136:137], v[134:135], v[96:99]
    s_waitcnt lgkmcnt(7)
    v_mfma_f32_32x32x16_bf16 v[32:47], v[100:103], a[132:135], v[32:47]
    s_add_u32 m0, s60, 19456
    s_nop 0
    buffer_load_dwordx4 v5, s[24:27], s66 offen lds
    ds_read_b128 a[140:143], v17 offset:0
    ds_read_b64_tr_b16 v[124:125], v21 offset:0
    ds_read_b64_tr_b16 v[126:127], v21 offset:640
    v_mfma_f32_32x32x16_bf16 v[48:63], v[104:107], a[132:135], v[48:63]
    ds_read_b64_tr_b16 v[128:129], v21 offset:256
    ds_read_b64_tr_b16 v[130:131], v21 offset:896
    ds_read_b64_tr_b16 v[132:133], v141 offset:0
    v_mfma_f32_32x32x16_bf16 v[64:79], v[108:111], a[132:135], v[64:79]
    s_mul_i32 s67, s101, 491520
    s_add_u32 s101, s101, 1
    s_cmp_eq_u32 s101, 5
    s_cselect_b32 s101, 0, s101
    s_add_u32 m0, s61, 40960
    s_nop 0
    buffer_load_dwordx4 v9, s[28:31], s67 offen lds
    ds_read_b64_tr_b16 v[134:135], v141 offset:640
    v_mfma_f32_4x4x4_16b_bf16 v[80:83], v[136:137], a[132:133], v[80:83]
    v_mfma_f32_4x4x4_16b_bf16 v[84:87], a[132:133], a[132:133], v[84:87]
    s_nop 0
    v_mfma_f32_4x4x4_16b_bf16 v[80:83], v[136:137], a[134:135], v[80:83]
    v_mfma_f32_4x4x4_16b_bf16 v[84:87], a[134:135], a[134:135], v[84:87]
    s_waitcnt lgkmcnt(7)
    v_mfma_f32_32x32x16_bf16 v[32:47], v[112:115], a[136:139], v[32:47]
    v_mfma_f32_32x32x16_bf16 v[48:63], v[116:119], a[136:139], v[48:63]
    s_add_u32 m0, s61, 41984
    s_nop 0
    buffer_load_dwordx4 v10, s[28:31], s67 offen lds
    v_mfma_f32_32x32x16_bf16 v[64:79], v[120:123], a[136:139], v[64:79]
    v_mfma_f32_4x4x4_16b_bf16 v[80:83], v[136:137], a[136:137], v[80:83]
    v_mfma_f32_4x4x4_16b_bf16 v[84:87], a[136:137], a[136:137], v[84:87]
    s_nop 0
    v_mfma_f32_4x4x4_16b_bf16 v[80:83], v[136:137], a[138:139], v[80:83]
    v_mfma_f32_4x4x4_16b_bf16 v[84:87], a[138:139], a[138:139], v[84:87]
    s_waitcnt lgkmcnt(0)
    v_mfma_f32_32x32x16_bf16 v[32:47], v[124:127], a[140:143], v[32:47]
    v_mfma_f32_32x32x16_bf16 v[48:63], v[128:131], a[140:143], v[48:63]
    s_add_u32 m0, s61, 43008
    s_mov_b32 exec_hi, 0
    buffer_load_dwordx4 v11, s[28:31], s67 offen lds
    s_mov_b32 exec_hi, -1
    v_mfma_f32_32x32x16_bf16 v[64:79], v[132:135], a[140:143], v[64:79]
    v_mfma_f32_4x4x4_16b_bf16 v[80:83], v[136:137], a[140:141], v[80:83]
    v_mfma_f32_4x4x4_16b_bf16 v[84:87], a[140:141], a[140:141], v[84:87]
    s_nop 0
    v_mfma_f32_4x4x4_16b_bf16 v[80:83], v[136:137], a[142:143], v[80:83]
    v_mfma_f32_4x4x4_16b_bf16 v[84:87], a[142:143], a[142:143], v[84:87]
    s_waitcnt vmcnt(3)
    s_barrier
    ds_read_b128 a[144:147], v14 offset:16384
    ds_read_b64_tr_b16 v[100:101], v18 offset:10240
    ds_read_b64_tr_b16 v[102:103], v18 offset:10880
    ds_read_b64_tr_b16 v[104:105], v18 offset:10496
    ds_read_b64_tr_b16 v[106:107], v18 offset:11136
    ds_read_b64_tr_b16 v[108:109], v138 offset:10240
    ds_read_b64_tr_b16 v[110:111], v138 offset:10880
    ds_read_b128 a[148:151], v15 offset:16384
    ds_read_b64_tr_b16 v[112:113], v19 offset:10240
    ds_read_b64_tr_b16 v[114:115], v19 offset:10880
    ds_read_b64_tr_b16 v[116:117], v19 offset:10496
    ds_read_b64_tr_b16 v[118:119], v19 offset:11136
    ds_read_b64_tr_b16 v[120:121], v139 offset:10240
    ds_read_b64_tr_b16 v[122:123], v139 offset:10880
    s_waitcnt lgkmcnt(7)
    v_mfma_f32_32x32x16_bf16 v[32:47], v[100:103], a[144:147], v[32:47]
    s_mul_i32 s67, s101, 491520
    s_add_u32 s101, s101, 1
    s_cmp_eq_u32 s101, 5
    s_cselect_b32 s101, 0, s101
    s_add_u32 m0, s61, 51200
    s_nop 0
    buffer_load_dwordx4 v9, s[28:31], s67 offen lds
    ds_read_b128 a[152:155], v16 offset:16384
    ds_read_b64_tr_b16 v[124:125], v20 offset:10240
    ds_read_b64_tr_b16 v[126:127], v20 offset:10880
    v_mfma_f32_32x32x16_bf16 v[48:63], v[104:107], a[144:147], v[48:63]
    ds_read_b64_tr_b16 v[128:129], v20 offset:10496
    ds_read_b64_tr_b16 v[130:131], v20 offset:11136
    ds_read_b64_tr_b16 v[132:133], v140 offset:10240
    v_mfma_f32_32x32x16_bf16 v[64:79], v[108:111], a[144:147], v[64:79]
    s_add_u32 m0, s61, 52224
    s_nop 0
    buffer_load_dwordx4 v10, s[28:31], s67 offen lds
    ds_read_b64_tr_b16 v[134:135], v140 offset:10880
    v_mfma_f32_4x4x4_16b_bf16 v[80:83], v[136:137], a[144:145], v[80:83]
    v_mfma_f32_4x4x4_16b_bf16 v[84:87], a[144:145], a[144:145], v[84:87]
    v_mfma_f32_4x4x4_16b_bf16 v[88:91], v[136:137], v[100:101], v[88:91]
    v_mfma_f32_4x4x4_16b_bf16 v[80:83], v[136:137], a[146:147], v[80:83]
    v_mfma_f32_4x4x4_16b_bf16 v[84:87], a[146:147], a[146:147], v[84:87]
    v_mfma_f32_4x4x4_16b_bf16 v[92:95], v[136:137], v[104:105], v[92:95]
    v_mfma_f32_4x4x4_16b_bf16 v[96:99], v[136:137], v[108:109], v[96:99]
    v_mfma_f32_4x4x4_16b_bf16 v[88:91], v[136:137], v[102:103], v[88:91]
    v_mfma_f32_4x4x4_16b_bf16 v[92:95], v[136:137], v[106:107], v[92:95]
    v_mfma_f32_4x4x4_16b_bf16 v[96:99], v[136:137], v[110:111], v[96:99]
    s_waitcnt lgkmcnt(7)
    v_mfma_f32_32x32x16_bf16 v[32:47], v[112:115], a[148:151], v[32:47]
    ds_read_b128 a[156:159], v17 offset:16384
    ds_read_b64_tr_b16 v[100:101], v21 offset:10240
    ds_read_b64_tr_b16 v[102:103], v21 offset:10880
    ds_read_b64_tr_b16 v[104:105], v21 offset:10496
    s_add_u32 m0, s61, 53248
    s_mov_b32 exec_hi, 0
    buffer_load_dwordx4 v11, s[28:31], s67 offen lds
    s_mov_b32 exec_hi, -1
    ds_read_b64_tr_b16 v[106:107], v21 offset:11136
    v_mfma_f32_32x32x16_bf16 v[48:63], v[116:119], a[148:151], v[48:63]
    ds_read_b64_tr_b16 v[108:109], v141 offset:10240
    ds_read_b64_tr_b16 v[110:111], v141 offset:10880
    v_mov_b32 v89, v88
    s_nop 1
    v_permlane32_swap_b32 v88, v89
    v_add_f32 v88, v88, v89
    v_mov_b32 v93, v92
    s_nop 1
    v_permlane32_swap_b32 v92, v93
    v_add_f32 v92, v92, v93
    v_mov_b32 v97, v96
    s_mul_i32 s67, s101, 491520
    s_add_u32 s101, s101, 1
    s_cmp_eq_u32 s101, 5
    s_cselect_b32 s101, 0, s101
    s_add_u32 m0, s61, 61440
    s_nop 0
    buffer_load_dwordx4 v9, s[28:31], s67 offen lds
    v_permlane32_swap_b32 v96, v97
    v_add_f32 v96, v96, v97
    v_mfma_f32_32x32x16_bf16 v[64:79], v[120:123], a[148:151], v[64:79]
    v_mov_b32 v89, v92
    v_mov_b32 v90, v96
    ds_write_b128 v152, v[88:91]
    v_mfma_f32_4x4x4_16b_bf16 v[80:83], v[136:137], a[148:149], v[80:83]
    v_mfma_f32_4x4x4_16b_bf16 v[84:87], a[148:149], a[148:149], v[84:87]
    s_nop 0
    v_mfma_f32_4x4x4_16b_bf16 v[80:83], v[136:137], a[150:151], v[80:83]
    v_mfma_f32_4x4x4_16b_bf16 v[84:87], a[150:151], a[150:151], v[84:87]
    s_waitcnt lgkmcnt(0)
    s_barrier
    s_mul_i32 s18, s3, 3072
    v_mfma_f32_32x32x16_bf16 v[32:47], v[124:127], a[152:155], v[32:47]
    s_add_u32 m0, s61, 62464
    s_nop 0
    buffer_load_dwordx4 v10, s[28:31], s67 offen lds
    ds_read_b128 v[184:187], v153 offset:0
    ds_read_b128 v[188:191], v153 offset:512
    v_mfma_f32_32x32x16_bf16 v[48:63], v[128:131], a[152:155], v[48:63]
    ds_read_b128 v[192:195], v153 offset:1024
    ds_read_b128 v[196:199], v153 offset:1536
    v_mfma_f32_32x32x16_bf16 v[64:79], v[132:135], a[152:155], v[64:79]
    s_add_u32 m0, s61, 63488
    s_mov_b32 exec_hi, 0
    buffer_load_dwordx4 v11, s[28:31], s67 offen lds
    s_mov_b32 exec_hi, -1
    v_mfma_f32_4x4x4_16b_bf16 v[80:83], v[136:137], a[152:153], v[80:83]
    v_mfma_f32_4x4x4_16b_bf16 v[84:87], a[152:153], a[152:153], v[84:87]
    s_nop 0
    v_mfma_f32_4x4x4_16b_bf16 v[80:83], v[136:137], a[154:155], v[80:83]
    v_mfma_f32_4x4x4_16b_bf16 v[84:87], a[154:155], a[154:155], v[84:87]
    s_nop 0
    v_mfma_f32_4x4x4_16b_bf16 v[80:83], v[136:137], a[156:157], v[80:83]
    v_mfma_f32_4x4x4_16b_bf16 v[84:87], a[156:157], a[156:157], v[84:87]
    s_nop 0
    v_mfma_f32_4x4x4_16b_bf16 v[80:83], v[136:137], a[158:159], v[80:83]
    v_mfma_f32_4x4x4_16b_bf16 v[84:87], a[158:159], a[158:159], v[84:87]
    v_mfma_f32_32x32x16_bf16 v[32:47], v[100:103], a[156:159], v[32:47]
    v_mfma_f32_32x32x16_bf16 v[64:79], v[108:111], a[156:159], v[64:79]
    s_waitcnt lgkmcnt(0)
    v_pk_add_f32 v[184:185], v[184:185], v[188:189]
    v_add_f32 v186, v186, v190
    v_pk_add_f32 v[192:193], v[192:193], v[196:197]
    v_add_f32 v194, v194, v198
    v_pk_add_f32 v[184:185], v[184:185], v[192:193]
    v_add_f32 v186, v186, v194
    ds_write_b32 v154, v184 offset:0
    ds_write_b32 v154, v185 offset:128
    ds_write_b32 v154, v186 offset:256
    ds_read_b128 v[184:187], v155 offset:0
    ds_read_b128 v[188:191], v155 offset:32
    ds_read_b128 v[192:195], v155 offset:64
    ds_read_b128 v[196:199], v155 offset:96
    ds_read_b128 v[200:203], v155 offset:256
    ds_read_b128 v[204:207], v155 offset:288
    ds_read_b128 v[208:211], v155 offset:128
    s_mul_i32 s67, s101, 491520
    s_add_u32 s101, s101, 1
    s_cmp_eq_u32 s101, 5
    s_cselect_b32 s101, 0, s101
    s_add_u32 m0, s61, 71680
    s_nop 0
    buffer_load_dwordx4 v9, s[28:31], s67 offen lds
    ds_read_b128 v[212:215], v155 offset:160
    ds_read_b128 v[216:219], v155 offset:192
    ds_read_b128 v[220:223], v155 offset:224
    v_mfma_f32_32x32x16_bf16 v[48:63], v[104:107], a[156:159], v[48:63]
    s_mov_b32 vcc_lo, 0x22222222
    s_mov_b32 vcc_hi, 0x22222222
    v_cndmask_b32 v84, v84, v85, vcc
    s_add_u32 m0, s61, 72704
    s_nop 0
    buffer_load_dwordx4 v10, s[28:31], s67 offen lds
    s_mov_b32 vcc_lo, 0x44444444
    s_mov_b32 vcc_hi, 0x44444444
    v_cndmask_b32 v84, v84, v86, vcc
    s_add_u32 m0, s61, 73728
    s_mov_b32 exec_hi, 0
    buffer_load_dwordx4 v11, s[28:31], s67 offen lds
    s_mov_b32 exec_hi, -1
    s_mov_b32 vcc_lo, 0x88888888
    s_mov_b32 vcc_hi, 0x88888888
    v_cndmask_b32 v84, v84, v87, vcc
    v_mov_b32 v81, v80
    s_nop 1
    v_permlane32_swap_b32 v80, v81
    v_add_f32 v80, v80, v81
    s_mul_i32 s67, s101, 491520
    s_add_u32 s101, s101, 1
    s_cmp_eq_u32 s101, 5
    s_cselect_b32 s101, 0, s101
    s_add_u32 m0, s61, 81920
    s_nop 0
    buffer_load_dwordx4 v9, s[28:31], s67 offen lds
    v_mov_b32 v85, v84
    s_nop 1
    v_permlane32_swap_b32 v84, v85
    v_add_f32 v84, v84, v85
    v_mul_f32 v150, 0xbacccccd, v80
    v_mul_f32 v81, 0x3acccccd, v84
    v_fma_f32 v81, -v150, v150, v81
    v_max_f32 v81, 0, v81
    s_add_u32 m0, s61, 82944
    s_nop 0
    buffer_load_dwordx4 v10, s[28:31], s67 offen lds
    v_add_f32 v81, 0x3727c5ac, v81
    v_rsq_f32 v158, v81
    s_waitcnt lgkmcnt(6)
    v_pk_fma_f32 v[32:33], v[184:185], v[150:151], v[32:33] op_sel_hi:[1,0,1]
    v_pk_fma_f32 v[34:35], v[186:187], v[150:151], v[34:35] op_sel_hi:[1,0,1]
    v_pk_fma_f32 v[36:37], v[188:189], v[150:151], v[36:37] op_sel_hi:[1,0,1]
    v_pk_fma_f32 v[38:39], v[190:191], v[150:151], v[38:39] op_sel_hi:[1,0,1]
    s_add_u32 m0, s61, 83968
    s_mov_b32 exec_hi, 0
    buffer_load_dwordx4 v11, s[28:31], s67 offen lds
    s_mov_b32 exec_hi, -1
    v_pk_fma_f32 v[40:41], v[192:193], v[150:151], v[40:41] op_sel_hi:[1,0,1]
    v_pk_fma_f32 v[42:43], v[194:195], v[150:151], v[42:43] op_sel_hi:[1,0,1]
    v_pk_fma_f32 v[44:45], v[196:197], v[150:151], v[44:45] op_sel_hi:[1,0,1]
    v_pk_fma_f32 v[46:47], v[198:199], v[150:151], v[46:47] op_sel_hi:[1,0,1]
    s_waitcnt lgkmcnt(4)
    v_pk_fma_f32 v[64:65], v[200:201], v[150:151], v[64:65] op_sel_hi:[1,0,1]
    v_pk_fma_f32 v[66:67], v[202:203], v[150:151], v[66:67] op_sel_hi:[1,0,1]
    v_pk_fma_f32 v[68:69], v[204:205], v[150:151], v[68:69] op_sel_hi:[1,0,1]
    s_mov_b64 s[52:53], s[96:97]
    s_mov_b32 s54, 819200
    s_lshl2_add_u32 s62, s2, s3
    s_mul_i32 s62, s62, 896
    s_mov_b64 exec, 0x7f
    buffer_load_dword v13, v12, s[52:55], s62 offen offset:0
    s_mov_b64 exec, -1
    v_pk_fma_f32 v[70:71], v[206:207], v[150:151], v[70:71] op_sel_hi:[1,0,1]
    v_cvt_pk_bf16_f32 v112, v32, v33
    v_cvt_pk_bf16_f32 v113, v34, v35
    v_cvt_pk_bf16_f32 v114, v36, v37
    v_cvt_pk_bf16_f32 v115, v38, v39
    v_cvt_pk_bf16_f32 v116, v40, v41
    v_cvt_pk_bf16_f32 v117, v42, v43
    v_cvt_pk_bf16_f32 v118, v44, v45
    s_mov_b64 s[52:53], s[20:21]
    s_mov_b32 s54, 1966080
    s_lshl2_add_u32 s62, s2, s3
    s_mul_i32 s62, s62, 1920
    s_mov_b64 exec, 0x7fff
    buffer_load_dword v13, v12, s[52:55], s62 offen offset:0
    s_mov_b64 exec, -1
    v_cvt_pk_bf16_f32 v119, v46, v47
    v_cvt_pk_bf16_f32 v120, v64, v65
    v_cvt_pk_bf16_f32 v121, v66, v67
    v_mov_b32 v122, 0
    v_mov_b32 v123, 0
    v_mul_f32 v160, 0x3fb8aa3b, v158
    s_waitcnt lgkmcnt(0)
    v_mfma_f32_32x32x16_bf16 v[164:179], v[232:235], v[112:115], 0
    s_lshl2_add_u32 s62, s2, s3
    s_mul_i32 s62, s62, 1920
    s_mov_b64 exec, 0x7fff
    buffer_load_dword v13, v12, s[36:39], s62 offen offset:0
    s_mov_b64 exec, -1
    v_pk_fma_f32 v[48:49], v[208:209], v[150:151], v[48:49] op_sel_hi:[1,0,1]
    v_pk_fma_f32 v[50:51], v[210:211], v[150:151], v[50:51] op_sel_hi:[1,0,1]
    v_pk_fma_f32 v[52:53], v[212:213], v[150:151], v[52:53] op_sel_hi:[1,0,1]
    v_pk_fma_f32 v[54:55], v[214:215], v[150:151], v[54:55] op_sel_hi:[1,0,1]
    v_pk_fma_f32 v[56:57], v[216:217], v[150:151], v[56:57] op_sel_hi:[1,0,1]
    v_mfma_f32_32x32x16_bf16 v[180:195], v[244:247], v[112:115], 0
    v_pk_fma_f32 v[58:59], v[218:219], v[150:151], v[58:59] op_sel_hi:[1,0,1]
    v_pk_fma_f32 v[60:61], v[220:221], v[150:151], v[60:61] op_sel_hi:[1,0,1]
    v_pk_fma_f32 v[62:63], v[222:223], v[150:151], v[62:63] op_sel_hi:[1,0,1]
    v_pk_mul_f32 v[48:49], v[48:49], v[158:159] op_sel_hi:[1,0]
    v_pk_mul_f32 v[50:51], v[50:51], v[158:159] op_sel_hi:[1,0]
    v_mfma_f32_32x32x16_bf16 v[164:179], v[236:239], v[116:119], v[164:179]
    v_pk_mul_f32 v[52:53], v[52:53], v[158:159] op_sel_hi:[1,0]
    v_pk_mul_f32 v[54:55], v[54:55], v[158:159] op_sel_hi:[1,0]
    v_pk_mul_f32 v[56:57], v[56:57], v[158:159] op_sel_hi:[1,0]
    v_pk_mul_f32 v[58:59], v[58:59], v[158:159] op_sel_hi:[1,0]
    v_pk_mul_f32 v[60:61], v[60:61], v[158:159] op_sel_hi:[1,0]
    v_mfma_f32_32x32x16_bf16 v[180:195], v[248:251], v[116:119], v[180:195]
    v_pk_mul_f32 v[62:63], v[62:63], v[158:159] op_sel_hi:[1,0]
    v_pk_mul_f32 v[68:69], v[68:69], v[158:159] op_sel_hi:[1,0]
    v_pk_mul_f32 v[70:71], v[70:71], v[158:159] op_sel_hi:[1,0]
    v_cvt_pk_bf16_f32 v124, v48, v49
    v_cvt_pk_bf16_f32 v125, v50, v51
    v_mfma_f32_32x32x16_bf16 v[164:179], v[240:243], v[120:123], v[164:179]
    v_cvt_pk_bf16_f32 v126, v52, v53
    v_cvt_pk_bf16_f32 v127, v54, v55
    v_cvt_pk_bf16_f32 v128, v56, v57
    v_cvt_pk_bf16_f32 v129, v58, v59
    v_cvt_pk_bf16_f32 v130, v60, v61
    v_mfma_f32_32x32x16_bf16 v[180:195], v[252:255], v[120:123], v[180:195]
    v_cvt_pk_bf16_f32 v131, v62, v63
    v_cvt_pk_bf16_f32 v132, v68, v69
    v_cvt_pk_bf16_f32 v133, v70, v71
    v_mov_b32 v134, v136
    v_mov_b32 v135, v136
    ds_write_b128 v224, v[124:127] offset:16384
    ds_write_b128 v225, v[128:131] offset:16384
    ds_write_b128 v226, v[132:135] offset:16384
    v_max3_f32 v72, v164, v165, v166
    v_min3_f32 v74, v164, v165, v166
    v_max3_f32 v72, v72, v167, v168
    v_min3_f32 v74, v74, v167, v168
    v_max3_f32 v72, v72, v169, v170
    v_min3_f32 v74, v74, v169, v170
    v_max3_f32 v72, v72, v171, v172
    v_min3_f32 v74, v74, v171, v172
    v_max3_f32 v72, v72, v173, v174
    v_min3_f32 v74, v74, v173, v174
    v_max3_f32 v72, v72, v175, v176
    v_min3_f32 v74, v74, v175, v176
    v_max3_f32 v72, v72, v177, v178
    v_min3_f32 v74, v74, v177, v178
    v_max3_f32 v72, v72, v179, v180
    v_min3_f32 v74, v74, v179, v180
    v_max3_f32 v72, v72, v181, v182
    v_min3_f32 v74, v74, v181, v182
    v_max_f32 v72, v72, v183
    v_min_f32 v74, v74, v183
    v_mul_f32 v72, v72, -v160
    v_mul_f32 v74, v74, v160
    v_pk_fma_f32 v[32:33], v[164:165], v[160:161], v[72:73] op_sel_hi:[1,0,0]
    v_pk_fma_f32 v[34:35], v[166:167], v[160:161], v[72:73] op_sel_hi:[1,0,0]
    v_pk_fma_f32 v[36:37], v[168:169], v[160:161], v[72:73] op_sel_hi:[1,0,0]
    v_pk_fma_f32 v[38:39], v[170:171], v[160:161], v[72:73] op_sel_hi:[1,0,0]
    v_pk_fma_f32 v[40:41], v[172:173], v[160:161], v[72:73] op_sel_hi:[1,0,0]
    v_pk_fma_f32 v[42:43], v[174:175], v[160:161], v[72:73] op_sel_hi:[1,0,0]
    v_pk_fma_f32 v[44:45], v[176:177], v[160:161], v[72:73] op_sel_hi:[1,0,0]
    v_pk_fma_f32 v[46:47], v[178:179], v[160:161], v[72:73] op_sel_hi:[1,0,0]
    v_pk_fma_f32 v[48:49], v[180:181], v[160:161], v[72:73] op_sel_hi:[1,0,0]
    v_pk_fma_f32 v[50:51], v[182:183], v[160:161], v[72:73] op_sel_hi:[1,0,0]
    v_exp_f32 v32, v32
    v_pk_fma_f32 v[52:53], v[164:165], v[160:161], v[74:75] op_sel_hi:[1,0,0] neg_lo:[1,0,0] neg_hi:[1,0,0]
    v_exp_f32 v33, v33
    v_exp_f32 v34, v34
    v_pk_fma_f32 v[54:55], v[166:167], v[160:161], v[74:75] op_sel_hi:[1,0,0] neg_lo:[1,0,0] neg_hi:[1,0,0]
    v_exp_f32 v35, v35
    v_exp_f32 v36, v36
    v_pk_fma_f32 v[56:57], v[168:169], v[160:161], v[74:75] op_sel_hi:[1,0,0] neg_lo:[1,0,0] neg_hi:[1,0,0]
    v_exp_f32 v37, v37
    v_exp_f32 v38, v38
    v_pk_fma_f32 v[58:59], v[170:171], v[160:161], v[74:75] op_sel_hi:[1,0,0] neg_lo:[1,0,0] neg_hi:[1,0,0]
    v_exp_f32 v39, v39
    v_exp_f32 v40, v40
    v_pk_fma_f32 v[60:61], v[172:173], v[160:161], v[74:75] op_sel_hi:[1,0,0] neg_lo:[1,0,0] neg_hi:[1,0,0]
    v_exp_f32 v41, v41
    v_exp_f32 v42, v42
    v_pk_fma_f32 v[62:63], v[174:175], v[160:161], v[74:75] op_sel_hi:[1,0,0] neg_lo:[1,0,0] neg_hi:[1,0,0]
    v_exp_f32 v43, v43
    v_exp_f32 v44, v44
    v_pk_fma_f32 v[64:65], v[176:177], v[160:161], v[74:75] op_sel_hi:[1,0,0] neg_lo:[1,0,0] neg_hi:[1,0,0]
    v_exp_f32 v45, v45
    v_exp_f32 v46, v46
    v_pk_fma_f32 v[66:67], v[178:179], v[160:161], v[74:75] op_sel_hi:[1,0,0] neg_lo:[1,0,0] neg_hi:[1,0,0]
    v_exp_f32 v47, v47
    v_exp_f32 v48, v48
    v_pk_fma_f32 v[68:69], v[180:181], v[160:161], v[74:75] op_sel_hi:[1,0,0] neg_lo:[1,0,0] neg_hi:[1,0,0]
    v_exp_f32 v49, v49
    v_exp_f32 v50, v50
    v_pk_fma_f32 v[70:71], v[182:183], v[160:161], v[74:75] op_sel_hi:[1,0,0] neg_lo:[1,0,0] neg_hi:[1,0,0]
    v_exp_f32 v51, v51
    v_exp_f32 v52, v52
    v_exp_f32 v53, v53
    v_exp_f32 v54, v54
    v_pk_add_f32 v[76:77], v[32:33], v[34:35]
    v_exp_f32 v55, v55
    v_exp_f32 v56, v56
    v_pk_add_f32 v[76:77], v[76:77], v[36:37]
    v_exp_f32 v57, v57
    v_exp_f32 v58, v58
    v_pk_add_f32 v[76:77], v[76:77], v[38:39]
    v_exp_f32 v59, v59
    v_exp_f32 v60, v60
    v_pk_add_f32 v[76:77], v[76:77], v[40:41]
    v_exp_f32 v61, v61
    v_exp_f32 v62, v62
    v_pk_add_f32 v[76:77], v[76:77], v[42:43]
    v_exp_f32 v63, v63
    v_exp_f32 v64, v64
    v_pk_add_f32 v[76:77], v[76:77], v[44:45]
    v_exp_f32 v65, v65
    v_exp_f32 v66, v66
    v_pk_add_f32 v[76:77], v[76:77], v[46:47]
    v_exp_f32 v67, v67
    v_exp_f32 v68, v68
    v_pk_add_f32 v[76:77], v[76:77], v[48:49]
    v_exp_f32 v69, v69
    v_exp_f32 v70, v70
    v_pk_add_f32 v[76:77], v[76:77], v[50:51]
    v_exp_f32 v71, v71
    v_add_f32 v76, v76, v77
    v_pk_add_f32 v[78:79], v[52:53], v[54:55]
    v_rcp_f32 v76, v76
    v_pk_add_f32 v[78:79], v[78:79], v[56:57]
    v_pk_add_f32 v[78:79], v[78:79], v[58:59]
    v_pk_add_f32 v[78:79], v[78:79], v[60:61]
    v_pk_add_f32 v[78:79], v[78:79], v[62:63]
    v_pk_add_f32 v[78:79], v[78:79], v[64:65]
    v_pk_add_f32 v[78:79], v[78:79], v[66:67]
    v_pk_add_f32 v[78:79], v[78:79], v[68:69]
    v_pk_add_f32 v[78:79], v[78:79], v[70:71]
    v_add_f32 v78, v78, v79
    v_rcp_f32 v78, v78
    v_pk_mul_f32 v[32:33], v[32:33], v[76:77] op_sel_hi:[1,0]
    v_pk_mul_f32 v[34:35], v[34:35], v[76:77] op_sel_hi:[1,0]
    v_pk_mul_f32 v[36:37], v[36:37], v[76:77] op_sel_hi:[1,0]
    v_pk_mul_f32 v[38:39], v[38:39], v[76:77] op_sel_hi:[1,0]
    v_pk_mul_f32 v[40:41], v[40:41], v[76:77] op_sel_hi:[1,0]
    v_pk_mul_f32 v[42:43], v[42:43], v[76:77] op_sel_hi:[1,0]
    v_pk_mul_f32 v[44:45], v[44:45], v[76:77] op_sel_hi:[1,0]
    v_pk_mul_f32 v[46:47], v[46:47], v[76:77] op_sel_hi:[1,0]
    v_pk_mul_f32 v[48:49], v[48:49], v[76:77] op_sel_hi:[1,0]
    v_pk_mul_f32 v[50:51], v[50:51], v[76:77] op_sel_hi:[1,0]
    v_cvt_pk_bf16_f32 v100, v32, v33
    v_cvt_pk_bf16_f32 v101, v34, v35
    v_cvt_pk_bf16_f32 v102, v36, v37
    v_cvt_pk_bf16_f32 v103, v38, v39
    ds_write_b128 v224, v[100:103]
    v_cvt_pk_bf16_f32 v104, v40, v41
    v_cvt_pk_bf16_f32 v105, v42, v43
    v_cvt_pk_bf16_f32 v106, v44, v45
    v_cvt_pk_bf16_f32 v107, v46, v47
    ds_write_b128 v225, v[104:107]
    v_cvt_pk_bf16_f32 v108, v48, v49
    v_cvt_pk_bf16_f32 v109, v50, v51
    ds_write_b64 v226, v[108:109]
    v_pk_mul_f32 v[52:53], v[52:53], v[78:79] op_sel_hi:[1,0]
    v_pk_mul_f32 v[54:55], v[54:55], v[78:79] op_sel_hi:[1,0]
    v_pk_mul_f32 v[56:57], v[56:57], v[78:79] op_sel_hi:[1,0]
    v_pk_mul_f32 v[58:59], v[58:59], v[78:79] op_sel_hi:[1,0]
    v_pk_mul_f32 v[60:61], v[60:61], v[78:79] op_sel_hi:[1,0]
    v_pk_mul_f32 v[62:63], v[62:63], v[78:79] op_sel_hi:[1,0]
    v_pk_mul_f32 v[64:65], v[64:65], v[78:79] op_sel_hi:[1,0]
    v_pk_mul_f32 v[66:67], v[66:67], v[78:79] op_sel_hi:[1,0]
    v_pk_mul_f32 v[68:69], v[68:69], v[78:79] op_sel_hi:[1,0]
    v_pk_mul_f32 v[70:71], v[70:71], v[78:79] op_sel_hi:[1,0]
    v_cvt_pk_bf16_f32 v112, v52, v53
    v_cvt_pk_bf16_f32 v113, v54, v55
    v_cvt_pk_bf16_f32 v114, v56, v57
    v_cvt_pk_bf16_f32 v115, v58, v59
    ds_write_b128 v224, v[112:115] offset:8192
    v_cvt_pk_bf16_f32 v116, v60, v61
    v_cvt_pk_bf16_f32 v117, v62, v63
    v_cvt_pk_bf16_f32 v118, v64, v65
    v_cvt_pk_bf16_f32 v119, v66, v67
    ds_write_b128 v225, v[116:119] offset:8192
    v_cvt_pk_bf16_f32 v120, v68, v69
    v_cvt_pk_bf16_f32 v121, v70, v71
    ds_write_b64 v226, v[120:121] offset:8192
    s_lshl4_add_u32 s12, s5, s4
    s_lshl2_add_u32 s12, s12, s3
    s_lshl_b32 s12, s12, 10
    s_add_u32 s12, s12, 65536
    s_waitcnt vmcnt(3)
    s_waitcnt lgkmcnt(0)
    s_barrier
    ds_read_b64_tr_b16 v[32:33], v227 offset:0
    ds_read_b64_tr_b16 v[34:35], v228 offset:0
    ds_read_b64_tr_b16 v[36:37], v229 offset:0
    ds_read_b64_tr_b16 v[38:39], v230 offset:0
    ds_read_b64_tr_b16 v[40:41], v227 offset:1024
    ds_read_b64_tr_b16 v[42:43], v228 offset:1024
    ds_read_b64_tr_b16 v[44:45], v229 offset:1024
    ds_read_b64_tr_b16 v[46:47], v230 offset:1024
    ds_read_b64_tr_b16 v[48:49], v227 offset:2048
    ds_read_b64_tr_b16 v[50:51], v228 offset:2048
    ds_read_b64_tr_b16 v[52:53], v229 offset:2048
    ds_read_b64_tr_b16 v[54:55], v230 offset:2048
    s_waitcnt lgkmcnt(8)
    v_mfma_f32_32x32x16_bf16 v[164:179], v[32:35], v[36:39], 0
    ds_read_b64_tr_b16 v[56:57], v227 offset:3072
    ds_read_b64_tr_b16 v[58:59], v228 offset:3072
    ds_read_b64_tr_b16 v[60:61], v229 offset:3072
    ds_read_b64_tr_b16 v[62:63], v230 offset:3072
    s_waitcnt lgkmcnt(8)
    v_mfma_f32_32x32x16_bf16 v[164:179], v[40:43], v[44:47], v[164:179]
    ds_read_b64_tr_b16 v[64:65], v227 offset:4096
    ds_read_b64_tr_b16 v[66:67], v228 offset:4096
    ds_read_b64_tr_b16 v[68:69], v229 offset:4096
    ds_read_b64_tr_b16 v[70:71], v230 offset:4096
    s_waitcnt lgkmcnt(8)
    v_mfma_f32_32x32x16_bf16 v[164:179], v[48:51], v[52:55], v[164:179]
    ds_read_b64_tr_b16 v[72:73], v227 offset:5120
    ds_read_b64_tr_b16 v[74:75], v228 offset:5120
    ds_read_b64_tr_b16 v[76:77], v229 offset:5120
    ds_read_b64_tr_b16 v[78:79], v230 offset:5120
    s_waitcnt lgkmcnt(8)
    v_mfma_f32_32x32x16_bf16 v[164:179], v[56:59], v[60:63], v[164:179]
    ds_read_b64_tr_b16 v[80:81], v227 offset:6144
    ds_read_b64_tr_b16 v[82:83], v228 offset:6144
    ds_read_b64_tr_b16 v[84:85], v229 offset:6144
    ds_read_b64_tr_b16 v[86:87], v230 offset:6144
    s_waitcnt lgkmcnt(8)
    v_mfma_f32_32x32x16_bf16 v[164:179], v[64:67], v[68:71], v[164:179]
    ds_read_b64_tr_b16 v[88:89], v227 offset:7168
    ds_read_b64_tr_b16 v[90:91], v228 offset:7168
    ds_read_b64_tr_b16 v[92:93], v229 offset:7168
    ds_read_b64_tr_b16 v[94:95], v230 offset:7168
    s_waitcnt lgkmcnt(8)
    v_mfma_f32_32x32x16_bf16 v[164:179], v[72:75], v[76:79], v[164:179]
    s_waitcnt lgkmcnt(4)
    v_mfma_f32_32x32x16_bf16 v[164:179], v[80:83], v[84:87], v[164:179]
    ds_read_b64_tr_b16 v[100:101], v142 offset:0
    ds_read_b64_tr_b16 v[102:103], v142 offset:320
    ds_read_b64_tr_b16 v[104:105], v146 offset:0
    ds_read_b64_tr_b16 v[106:107], v146 offset:320
    s_waitcnt lgkmcnt(4)
    v_mfma_f32_32x32x16_bf16 v[164:179], v[88:91], v[92:95], v[164:179]
    ds_read_b64_tr_b16 v[108:109], v143 offset:0
    ds_read_b64_tr_b16 v[110:111], v143 offset:320
    ds_read_b64_tr_b16 v[112:113], v147 offset:0
    ds_read_b64_tr_b16 v[114:115], v147 offset:320
    s_nop 7
    v_cvt_pk_bf16_f32 v184, v164, v165
    v_cvt_pk_bf16_f32 v185, v166, v167
    v_cvt_pk_bf16_f32 v186, v168, v169
    v_cvt_pk_bf16_f32 v187, v170, v171
    v_cvt_pk_bf16_f32 v188, v172, v173
    v_cvt_pk_bf16_f32 v189, v174, v175
    s_mov_b32 exec_lo, 0xffffff
    s_mov_b32 exec_hi, 0xffffff
    buffer_store_dwordx4 v[184:187], v162, s[32:35], s12 offen sc1
    s_mov_b32 exec_lo, 0xffffffff
    s_mov_b32 exec_hi, 0x0
    buffer_store_dwordx2 v[188:189], v163, s[32:35], s12 offen offset:768 sc1
    s_mov_b64 exec, -1
    s_lshl2_add_u32 s17, s5, s3
    s_lshl_b32 s17, s17, 7
    s_lshl2_add_u32 s19, s8, s3
    s_mul_i32 s68, s19, 61440
    s_add_u32 s68, s68, 15728640
    s_mul_i32 s19, s19, 25600
    s_add_u32 s19, s19, 14680064
    v_accvgpr_read_b32 v198, a232
    s_waitcnt lgkmcnt(4)
    v_mfma_f32_32x32x16_bf16 v[32:47], v[100:103], a[0:3], 0
    s_mul_i32 s16, s3, 5120
    s_add_u32 s16, s16, 106496
    s_cmp_eq_u32 s3, 3
    s_cselect_b32 s16, 98304, s16
    v_add_u32 v195, s16, v1
    ds_read_b64_tr_b16 v[116:117], v144 offset:0
    ds_read_b64_tr_b16 v[118:119], v144 offset:320
    ds_read_b64_tr_b16 v[120:121], v148 offset:0
    ds_read_b64_tr_b16 v[122:123], v148 offset:320
    v_add_u32 v196, s0, v1
    v_mfma_f32_32x32x16_bf16 v[48:63], v[104:107], a[0:3], 0
    v_mov_b32 v197, s99
    v_lshrrev_b32 v25, 4, v0
    v_mfma_f32_4x4x4_16b_bf16 v[88:91], v[136:137], v[100:101], 0
    v_mfma_f32_4x4x4_16b_bf16 v[92:95], v[136:137], v[104:105], 0
    s_nop 0
    v_mfma_f32_4x4x4_16b_bf16 v[88:91], v[136:137], v[102:103], v[88:91]
    v_mfma_f32_4x4x4_16b_bf16 v[92:95], v[136:137], v[106:107], v[92:95]
    s_waitcnt lgkmcnt(4)
    v_mfma_f32_32x32x16_bf16 v[32:47], v[108:111], a[4:7], v[32:47]
    v_bfe_u32 v26, v0, 2, 2
    v_lshl_add_u32 v25, v25, 3, v26
    ds_read_b64_tr_b16 v[100:101], v145 offset:0
    ds_read_b64_tr_b16 v[102:103], v145 offset:320
    ds_read_b64_tr_b16 v[104:105], v149 offset:0
    ds_read_b64_tr_b16 v[106:107], v149 offset:320
    v_lshlrev_b32 v25, 5, v25
    v_mfma_f32_32x32x16_bf16 v[48:63], v[112:115], a[4:7], v[48:63]
    v_add_u32 v25, s16, v25
    v_and_b32 v26, 3, v0
    s_waitcnt lgkmcnt(4)
    v_mfma_f32_32x32x16_bf16 v[32:47], v[116:119], a[8:11], v[32:47]
    v_mul_u32_u24 v26, 40, v26
    v_add_u32 v27, 0, v26
    ds_read_b64_tr_b16 v[108:109], v142 offset:5120
    ds_read_b64_tr_b16 v[110:111], v142 offset:5440
    ds_read_b64_tr_b16 v[112:113], v146 offset:5120
    ds_read_b64_tr_b16 v[114:115], v146 offset:5440
    v_lshrrev_b32 v28, 5, v27
    v_mfma_f32_32x32x16_bf16 v[48:63], v[120:123], a[8:11], v[48:63]
    v_and_b32 v27, 31, v27
    v_lshl_add_u32 v27, v28, 10, v27
    s_waitcnt lgkmcnt(4)
    v_mfma_f32_32x32x16_bf16 v[32:47], v[100:103], a[12:15], v[32:47]
    v_add_u32 v190, v25, v27
    v_add_u32 v27, 8, v26
    ds_read_b64_tr_b16 v[116:117], v143 offset:5120
    ds_read_b64_tr_b16 v[118:119], v143 offset:5440
    ds_read_b64_tr_b16 v[120:121], v147 offset:5120
    ds_read_b64_tr_b16 v[122:123], v147 offset:5440
    v_lshrrev_b32 v28, 5, v27
    v_mfma_f32_32x32x16_bf16 v[48:63], v[104:107], a[12:15], v[48:63]
    v_and_b32 v27, 31, v27
    v_lshl_add_u32 v27, v28, 10, v27
    s_waitcnt lgkmcnt(4)
    v_mfma_f32_32x32x16_bf16 v[32:47], v[108:111], a[16:19], v[32:47]
    v_add_u32 v191, v25, v27
    v_add_u32 v27, 16, v26
    ds_read_b64_tr_b16 v[100:101], v144 offset:5120
    ds_read_b64_tr_b16 v[102:103], v144 offset:5440
    ds_read_b64_tr_b16 v[104:105], v148 offset:5120
    ds_read_b64_tr_b16 v[106:107], v148 offset:5440
    v_lshrrev_b32 v28, 5, v27
    v_mfma_f32_32x32x16_bf16 v[48:63], v[112:115], a[16:19], v[48:63]
    v_and_b32 v27, 31, v27
    v_lshl_add_u32 v27, v28, 10, v27
    v_mfma_f32_4x4x4_16b_bf16 v[88:91], v[136:137], v[108:109], v[88:91]
    v_mfma_f32_4x4x4_16b_bf16 v[92:95], v[136:137], v[112:113], v[92:95]
    s_nop 0
    v_mfma_f32_4x4x4_16b_bf16 v[88:91], v[136:137], v[110:111], v[88:91]
    v_mfma_f32_4x4x4_16b_bf16 v[92:95], v[136:137], v[114:115], v[92:95]
    s_waitcnt lgkmcnt(4)
    v_mfma_f32_32x32x16_bf16 v[32:47], v[116:119], a[20:23], v[32:47]
    v_add_u32 v192, v25, v27
    v_add_u32 v27, 24, v26
    ds_read_b64_tr_b16 v[108:109], v145 offset:5120
    ds_read_b64_tr_b16 v[110:111], v145 offset:5440
    ds_read_b64_tr_b16 v[112:113], v149 offset:5120
    ds_read_b64_tr_b16 v[114:115], v149 offset:5440
    v_lshrrev_b32 v28, 5, v27
    v_mfma_f32_32x32x16_bf16 v[48:63], v[120:123], a[20:23], v[48:63]
    v_and_b32 v27, 31, v27
    v_lshl_add_u32 v27, v28, 10, v27
    s_waitcnt lgkmcnt(4)
    v_mfma_f32_32x32x16_bf16 v[32:47], v[100:103], a[24:27], v[32:47]
    buffer_load_dwordx4 a[236:239], v198, s[44:47], s98 offen offset:0
    v_add_u32 v193, v25, v27
    v_add_u32 v27, 32, v26
    ds_read_b64_tr_b16 v[116:117], v142 offset:10240
    buffer_load_dwordx4 a[240:243], v198, s[44:47], s98 offen offset:32
    ds_read_b64_tr_b16 v[118:119], v142 offset:10560
    ds_read_b64_tr_b16 v[120:121], v146 offset:10240
    ds_read_b64_tr_b16 v[122:123], v146 offset:10560
    v_lshrrev_b32 v28, 5, v27
    v_mfma_f32_32x32x16_bf16 v[48:63], v[104:107], a[24:27], v[48:63]
    v_and_b32 v27, 31, v27
    v_lshl_add_u32 v27, v28, 10, v27
    s_waitcnt lgkmcnt(4)
    v_mfma_f32_32x32x16_bf16 v[32:47], v[108:111], a[28:31], v[32:47]
    v_add_u32 v194, v25, v27
    s_lshl1_add_u32 s14, s6, s7
    ds_read_b64_tr_b16 v[100:101], v143 offset:10240
    ds_read_b64_tr_b16 v[102:103], v143 offset:10560
    ds_read_b64_tr_b16 v[104:105], v147 offset:10240
    ds_read_b64_tr_b16 v[106:107], v147 offset:10560
    s_lshl2_add_u32 s14, s14, s3
    v_mfma_f32_32x32x16_bf16 v[48:63], v[112:115], a[28:31], v[48:63]
    buffer_load_dwordx4 a[244:247], v198, s[44:47], s98 offen offset:64
    s_mul_i32 s14, s14, 20480
    s_mul_i32 s15, s8, 160
    s_waitcnt lgkmcnt(4)
    v_mfma_f32_32x32x16_bf16 v[32:47], v[116:119], a[32:35], v[32:47]
    s_add_u32 s14, s14, s15
    v_and_b32 v25, 15, v0
    ds_read_b64_tr_b16 v[108:109], v144 offset:10240
    ds_read_b64_tr_b16 v[110:111], v144 offset:10560
    ds_read_b64_tr_b16 v[112:113], v148 offset:10240
    ds_read_b64_tr_b16 v[114:115], v148 offset:10560
    v_mul_u32_u24 v25, 1280, v25
    v_mfma_f32_32x32x16_bf16 v[48:63], v[120:123], a[32:35], v[48:63]
    v_lshrrev_b32 v28, 4, v0
    v_mul_u32_u24 v28, 40, v28
    v_mfma_f32_4x4x4_16b_bf16 v[88:91], v[136:137], v[116:117], v[88:91]
    v_mfma_f32_4x4x4_16b_bf16 v[92:95], v[136:137], v[120:121], v[92:95]
    s_nop 0
    v_mfma_f32_4x4x4_16b_bf16 v[88:91], v[136:137], v[118:119], v[88:91]
    v_mfma_f32_4x4x4_16b_bf16 v[92:95], v[136:137], v[122:123], v[92:95]
    s_waitcnt lgkmcnt(4)
    v_mfma_f32_32x32x16_bf16 v[32:47], v[100:103], a[36:39], v[32:47]
    v_add3_u32 v2, v25, v28, s14
    s_lshl_b32 s12, s5, 16
    ds_read_b64_tr_b16 v[116:117], v145 offset:10240
    buffer_load_dwordx4 a[248:251], v198, s[44:47], s98 offen offset:96
    ds_read_b64_tr_b16 v[118:119], v145 offset:10560
    ds_read_b64_tr_b16 v[120:121], v149 offset:10240
    ds_read_b64_tr_b16 v[122:123], v149 offset:10560
    s_lshl_b32 s13, s3, 10
    v_mfma_f32_32x32x16_bf16 v[48:63], v[104:107], a[36:39], v[48:63]
    s_add_u32 s12, s12, s13
    s_add_u32 s12, s12, 65536
    s_waitcnt lgkmcnt(4)
    v_mfma_f32_32x32x16_bf16 v[32:47], v[108:111], a[40:43], v[32:47]
    s_lshl2_add_u32 s15, s8, s3
    s_add_u32 s16, s15, 416
    ds_read_b64_tr_b16 v[100:101], v142 offset:15360
    ds_read_b64_tr_b16 v[102:103], v142 offset:15680
    ds_read_b64_tr_b16 v[104:105], v146 offset:15360
    ds_read_b64_tr_b16 v[106:107], v146 offset:15680
    s_add_u32 s15, s15, 384
    v_mfma_f32_32x32x16_bf16 v[48:63], v[112:115], a[40:43], v[48:63]
    buffer_load_dwordx4 a[252:255], v198, s[44:47], s98 offen offset:128
    s_lshl_b32 s15, s15, 7
    s_lshl_b32 s16, s16, 7
    s_waitcnt lgkmcnt(4)
    v_mfma_f32_32x32x16_bf16 v[32:47], v[116:119], a[44:47], v[32:47]
    ds_read_b64_tr_b16 v[108:109], v143 offset:15360
    ds_read_b64_tr_b16 v[110:111], v143 offset:15680
    ds_read_b64_tr_b16 v[112:113], v147 offset:15360
    ds_read_b64_tr_b16 v[114:115], v147 offset:15680
    v_mfma_f32_32x32x16_bf16 v[48:63], v[120:123], a[44:47], v[48:63]
    s_waitcnt lgkmcnt(4)
    v_mfma_f32_32x32x16_bf16 v[32:47], v[100:103], a[48:51], v[32:47]
    ds_read_b64_tr_b16 v[116:117], v144 offset:15360
    ds_read_b64_tr_b16 v[118:119], v144 offset:15680
    s_mov_b32 s67, 786432
    s_add_u32 m0, s18, 49152
    s_nop 0
    buffer_load_dwordx4 v22, s[36:39], s67 offen lds
    ds_read_b64_tr_b16 v[120:121], v148 offset:15360
    ds_read_b64_tr_b16 v[122:123], v148 offset:15680
    v_mfma_f32_32x32x16_bf16 v[48:63], v[104:107], a[48:51], v[48:63]
    v_mfma_f32_4x4x4_16b_bf16 v[88:91], v[136:137], v[100:101], v[88:91]
    v_mfma_f32_4x4x4_16b_bf16 v[92:95], v[136:137], v[104:105], v[92:95]
    s_nop 0
    v_mfma_f32_4x4x4_16b_bf16 v[88:91], v[136:137], v[102:103], v[88:91]
    v_mfma_f32_4x4x4_16b_bf16 v[92:95], v[136:137], v[106:107], v[92:95]
    s_waitcnt lgkmcnt(4)
    v_mfma_f32_32x32x16_bf16 v[32:47], v[108:111], a[52:55], v[32:47]
    ds_read_b64_tr_b16 v[100:101], v145 offset:15360
    ds_read_b64_tr_b16 v[102:103], v145 offset:15680
    ds_read_b64_tr_b16 v[104:105], v149 offset:15360
    ds_read_b64_tr_b16 v[106:107], v149 offset:15680
    v_mfma_f32_32x32x16_bf16 v[48:63], v[112:115], a[52:55], v[48:63]
    s_waitcnt vmcnt(6)
    s_mov_b32 s65, 1
    s_atomic_add s65, s[32:33], s17
    s_waitcnt lgkmcnt(4)
    v_mfma_f32_32x32x16_bf16 v[32:47], v[116:119], a[56:59], v[32:47]
    s_mov_b32 s67, 786432
    s_add_u32 m0, s18, 50176
    s_nop 0
    buffer_load_dwordx4 v23, s[36:39], s67 offen lds
    ds_read_b64_tr_b16 v[108:109], v142 offset:20480
    ds_read_b64_tr_b16 v[110:111], v142 offset:20800
    ds_read_b64_tr_b16 v[112:113], v146 offset:20480
    ds_read_b64_tr_b16 v[114:115], v146 offset:20800
    v_mfma_f32_32x32x16_bf16 v[48:63], v[120:123], a[56:59], v[48:63]
    s_barrier
    s_waitcnt lgkmcnt(4)
    v_mfma_f32_32x32x16_bf16 v[32:47], v[100:103], a[60:63], v[32:47]
    s_mov_b32 s67, 786432
    s_add_u32 m0, s18, 51200
    s_nop 0
    buffer_load_dwordx4 v24, s[36:39], s67 offen lds
    ds_read_b64_tr_b16 v[116:117], v143 offset:20480
    ds_read_b64_tr_b16 v[118:119], v143 offset:20800
    ds_read_b64_tr_b16 v[120:121], v147 offset:20480
    ds_read_b64_tr_b16 v[122:123], v147 offset:20800
    v_mfma_f32_32x32x16_bf16 v[48:63], v[104:107], a[60:63], v[48:63]
    s_waitcnt lgkmcnt(4)
    v_mfma_f32_32x32x16_bf16 v[32:47], v[108:111], a[64:67], v[32:47]
    ds_read_b64_tr_b16 v[100:101], v144 offset:20480
    ds_read_b64_tr_b16 v[102:103], v144 offset:20800
    ds_read_b64_tr_b16 v[104:105], v148 offset:20480
    ds_read_b64_tr_b16 v[106:107], v148 offset:20800
    v_mfma_f32_32x32x16_bf16 v[48:63], v[112:115], a[64:67], v[48:63]
    s_mov_b32 s67, 983040
    s_add_u32 m0, s18, 61440
    s_nop 0
    buffer_load_dwordx4 v22, s[36:39], s67 offen lds
    v_mfma_f32_4x4x4_16b_bf16 v[88:91], v[136:137], v[108:109], v[88:91]
    v_mfma_f32_4x4x4_16b_bf16 v[92:95], v[136:137], v[112:113], v[92:95]
    s_nop 0
    v_mfma_f32_4x4x4_16b_bf16 v[88:91], v[136:137], v[110:111], v[88:91]
    v_mfma_f32_4x4x4_16b_bf16 v[92:95], v[136:137], v[114:115], v[92:95]
    s_waitcnt lgkmcnt(4)
    v_mfma_f32_32x32x16_bf16 v[32:47], v[116:119], a[68:71], v[32:47]
    ds_read_b64_tr_b16 v[108:109], v145 offset:20480
    ds_read_b64_tr_b16 v[110:111], v145 offset:20800
    ds_read_b64_tr_b16 v[112:113], v149 offset:20480
    ds_read_b64_tr_b16 v[114:115], v149 offset:20800
    v_mfma_f32_32x32x16_bf16 v[48:63], v[120:123], a[68:71], v[48:63]
    s_waitcnt lgkmcnt(4)
    v_mfma_f32_32x32x16_bf16 v[32:47], v[100:103], a[72:75], v[32:47]
    s_mov_b32 s67, 983040
    s_add_u32 m0, s18, 62464
    s_nop 0
    buffer_load_dwordx4 v23, s[36:39], s67 offen lds
    ds_read_b64_tr_b16 v[116:117], v142 offset:25600
    ds_read_b64_tr_b16 v[118:119], v142 offset:25920
    ds_read_b64_tr_b16 v[120:121], v146 offset:25600
    ds_read_b64_tr_b16 v[122:123], v146 offset:25920
    v_mfma_f32_32x32x16_bf16 v[48:63], v[104:107], a[72:75], v[48:63]
    s_waitcnt lgkmcnt(4)
    v_mfma_f32_32x32x16_bf16 v[32:47], v[108:111], a[76:79], v[32:47]
    s_waitcnt vmcnt(5)
    ds_read_b64_tr_b16 v[100:101], v143 offset:25600
    ds_read_b64_tr_b16 v[102:103], v143 offset:25920
    ds_read_b64_tr_b16 v[104:105], v147 offset:25600
    ds_read_b64_tr_b16 v[106:107], v147 offset:25920
    v_mfma_f32_32x32x16_bf16 v[48:63], v[112:115], a[76:79], v[48:63]
    s_mov_b32 s67, 983040
    s_add_u32 m0, s18, 63488
    s_nop 0
    buffer_load_dwordx4 v24, s[36:39], s67 offen lds
    ds_write_b128 v195, a[236:239] offset:0
    s_waitcnt lgkmcnt(5)
    v_mfma_f32_32x32x16_bf16 v[32:47], v[116:119], a[80:83], v[32:47]
    ds_write_b128 v195, a[240:243] offset:1024
    ds_read_b64_tr_b16 v[108:109], v144 offset:25600
    ds_read_b64_tr_b16 v[110:111], v144 offset:25920
    ds_read_b64_tr_b16 v[112:113], v148 offset:25600
    ds_read_b64_tr_b16 v[114:115], v148 offset:25920
    v_mfma_f32_32x32x16_bf16 v[48:63], v[120:123], a[80:83], v[48:63]
    ds_write_b128 v195, a[244:247] offset:2048
    v_mfma_f32_4x4x4_16b_bf16 v[88:91], v[136:137], v[116:117], v[88:91]
    v_mfma_f32_4x4x4_16b_bf16 v[92:95], v[136:137], v[120:121], v[92:95]
    s_nop 0
    v_mfma_f32_4x4x4_16b_bf16 v[88:91], v[136:137], v[118:119], v[88:91]
    v_mfma_f32_4x4x4_16b_bf16 v[92:95], v[136:137], v[122:123], v[92:95]
    s_waitcnt lgkmcnt(7)
    v_mfma_f32_32x32x16_bf16 v[32:47], v[100:103], a[84:87], v[32:47]
    ds_write_b128 v195, a[248:251] offset:3072
    ds_read_b64_tr_b16 v[116:117], v145 offset:25600
    s_mov_b32 s67, 1179648
    s_add_u32 m0, s18, 73728
    s_nop 0
    buffer_load_dwordx4 v22, s[36:39], s67 offen lds
    ds_read_b64_tr_b16 v[118:119], v145 offset:25920
    ds_read_b64_tr_b16 v[120:121], v149 offset:25600
    ds_read_b64_tr_b16 v[122:123], v149 offset:25920
    v_mfma_f32_32x32x16_bf16 v[48:63], v[104:107], a[84:87], v[48:63]
    ds_write_b128 v195, a[252:255] offset:4096
    s_waitcnt lgkmcnt(7)
    v_mfma_f32_32x32x16_bf16 v[32:47], v[108:111], a[88:91], v[32:47]
    ds_read_b64_tr_b16 v[164:165], v190 offset:0
    ds_read_b64_tr_b16 v[166:167], v190 offset:128
    ds_read_b64_tr_b16 v[100:101], v142 offset:30720
    ds_read_b64_tr_b16 v[102:103], v142 offset:31040
    ds_read_b64_tr_b16 v[104:105], v146 offset:30720
    ds_read_b64_tr_b16 v[106:107], v146 offset:31040
    v_mfma_f32_32x32x16_bf16 v[48:63], v[112:115], a[88:91], v[48:63]
    s_mov_b32 s67, 1179648
    s_add_u32 m0, s18, 74752
    s_nop 0
    buffer_load_dwordx4 v23, s[36:39], s67 offen lds
    ds_read_b64_tr_b16 v[168:169], v191 offset:0
    ds_read_b64_tr_b16 v[170:171], v191 offset:128
    s_waitcnt lgkmcnt(9)
    v_mfma_f32_32x32x16_bf16 v[32:47], v[116:119], a[92:95], v[32:47]
    ds_read_b64_tr_b16 v[172:173], v192 offset:0
    ds_read_b64_tr_b16 v[174:175], v192 offset:128
    ds_read_b64_tr_b16 v[108:109], v143 offset:30720
    ds_read_b64_tr_b16 v[110:111], v143 offset:31040
    ds_read_b64_tr_b16 v[112:113], v147 offset:30720
    ds_read_b64_tr_b16 v[114:115], v147 offset:31040
    v_mfma_f32_32x32x16_bf16 v[48:63], v[120:123], a[92:95], v[48:63]
    ds_read_b64_tr_b16 v[176:177], v193 offset:0
    ds_read_b64_tr_b16 v[178:179], v193 offset:128
    s_waitcnt lgkmcnt(10)
    v_mfma_f32_32x32x16_bf16 v[32:47], v[100:103], a[96:99], v[32:47]
    ds_read_b64_tr_b16 v[180:181], v194 offset:0
    ds_read_b64_tr_b16 v[182:183], v194 offset:128
    ds_read_b64_tr_b16 v[116:117], v144 offset:30720
    ds_read_b64_tr_b16 v[118:119], v144 offset:31040
    s_mov_b32 s67, 1179648
    s_add_u32 m0, s18, 75776
    s_nop 0
    buffer_load_dwordx4 v24, s[36:39], s67 offen lds
    ds_read_b64_tr_b16 v[120:121], v148 offset:30720
    ds_read_b64_tr_b16 v[122:123], v148 offset:31040
    v_mfma_f32_32x32x16_bf16 v[48:63], v[104:107], a[96:99], v[48:63]
    s_nop 0
    v_mfma_f32_4x4x4_16b_bf16 v[88:91], v[136:137], v[100:101], v[88:91]
    v_mfma_f32_4x4x4_16b_bf16 v[92:95], v[136:137], v[104:105], v[92:95]
    s_nop 0
    v_mfma_f32_4x4x4_16b_bf16 v[88:91], v[136:137], v[102:103], v[88:91]
    v_mfma_f32_4x4x4_16b_bf16 v[92:95], v[136:137], v[106:107], v[92:95]
    s_waitcnt lgkmcnt(8)
    v_mfma_f32_32x32x16_bf16 v[32:47], v[108:111], a[100:103], v[32:47]
    s_nop 0
    ds_read_b64_tr_b16 v[100:101], v145 offset:30720
    ds_read_b64_tr_b16 v[102:103], v145 offset:31040
    ds_read_b64_tr_b16 v[104:105], v149 offset:30720
    ds_read_b64_tr_b16 v[106:107], v149 offset:31040
    v_mfma_f32_32x32x16_bf16 v[48:63], v[112:115], a[100:103], v[48:63]
    buffer_store_dwordx4 v[164:167], v196, s[48:51], 0 offen offset:0 sc1
    s_waitcnt lgkmcnt(4)
    v_mfma_f32_32x32x16_bf16 v[32:47], v[116:119], a[104:107], v[32:47]
    s_mov_b32 s67, 1376256
    s_add_u32 m0, s18, 86016
    s_nop 0
    buffer_load_dwordx4 v22, s[36:39], s67 offen lds
    buffer_store_dwordx4 v[168:171], v196, s[48:51], 0 offen offset:1024 sc1
    ds_read_b64_tr_b16 v[108:109], v142 offset:35840
    ds_read_b64_tr_b16 v[110:111], v142 offset:36160
    ds_read_b64_tr_b16 v[112:113], v146 offset:35840
    ds_read_b64_tr_b16 v[114:115], v146 offset:36160
    v_mfma_f32_32x32x16_bf16 v[48:63], v[120:123], a[104:107], v[48:63]
    buffer_store_dwordx4 v[172:175], v196, s[48:51], 0 offen offset:2048 sc1
    s_waitcnt lgkmcnt(4)
    v_mfma_f32_32x32x16_bf16 v[32:47], v[100:103], a[108:111], v[32:47]
    buffer_store_dwordx4 v[176:179], v196, s[48:51], 0 offen offset:3072 sc1
    ds_read_b64_tr_b16 v[116:117], v143 offset:35840
    ds_read_b64_tr_b16 v[118:119], v143 offset:36160
    ds_read_b64_tr_b16 v[120:121], v147 offset:35840
    s_mov_b32 s67, 1376256
    s_add_u32 m0, s18, 87040
    s_nop 0
    buffer_load_dwordx4 v23, s[36:39], s67 offen lds
    ds_read_b64_tr_b16 v[122:123], v147 offset:36160
    v_mfma_f32_32x32x16_bf16 v[48:63], v[104:107], a[108:111], v[48:63]
    v_add_u32 v196, 4096, v196
    buffer_store_dwordx4 v[180:183], v196, s[48:51], 0 offen offset:0 sc1
    s_waitcnt lgkmcnt(4)
    v_mfma_f32_32x32x16_bf16 v[32:47], v[108:111], a[112:115], v[32:47]
    ds_read_b64_tr_b16 v[100:101], v144 offset:35840
    ds_read_b64_tr_b16 v[102:103], v144 offset:36160
    ds_read_b64_tr_b16 v[104:105], v148 offset:35840
    ds_read_b64_tr_b16 v[106:107], v148 offset:36160
    v_mfma_f32_32x32x16_bf16 v[48:63], v[112:115], a[112:115], v[48:63]
    v_mfma_f32_4x4x4_16b_bf16 v[88:91], v[136:137], v[108:109], v[88:91]
    v_mfma_f32_4x4x4_16b_bf16 v[92:95], v[136:137], v[112:113], v[92:95]
    s_nop 0
    v_mfma_f32_4x4x4_16b_bf16 v[88:91], v[136:137], v[110:111], v[88:91]
    v_mfma_f32_4x4x4_16b_bf16 v[92:95], v[136:137], v[114:115], v[92:95]
    s_mov_b32 s62, 0
    s_atomic_add s62, s[32:33], s17 glc
    s_waitcnt lgkmcnt(4)
    v_mfma_f32_32x32x16_bf16 v[32:47], v[116:119], a[116:119], v[32:47]
    s_mov_b32 s67, 1376256
    s_add_u32 m0, s18, 88064
    s_nop 0
    buffer_load_dwordx4 v24, s[36:39], s67 offen lds
    ds_read_b64_tr_b16 v[108:109], v145 offset:35840
    ds_read_b64_tr_b16 v[110:111], v145 offset:36160
    ds_read_b64_tr_b16 v[112:113], v149 offset:35840
    ds_read_b64_tr_b16 v[114:115], v149 offset:36160
    v_mfma_f32_32x32x16_bf16 v[48:63], v[120:123], a[116:119], v[48:63]
    s_waitcnt lgkmcnt(4)
    v_mfma_f32_32x32x16_bf16 v[32:47], v[100:103], a[120:123], v[32:47]
    ds_read_b64_tr_b16 v[116:117], v142 offset:40960
    ds_read_b64_tr_b16 v[118:119], v142 offset:41280
    s_mov_b32 s67, 0
    s_add_u32 m0, s18, 0
    s_nop 0
    buffer_load_dwordx4 v22, s[36:39], s67 offen lds
    ds_read_b64_tr_b16 v[120:121], v146 offset:40960
    ds_read_b64_tr_b16 v[122:123], v146 offset:41280
    v_mfma_f32_32x32x16_bf16 v[48:63], v[104:107], a[120:123], v[48:63]
    s_waitcnt lgkmcnt(4)
    v_mfma_f32_32x32x16_bf16 v[32:47], v[108:111], a[124:127], v[32:47]
    ds_read_b64_tr_b16 v[100:101], v143 offset:40960
    ds_read_b64_tr_b16 v[102:103], v143 offset:41280
    ds_read_b64_tr_b16 v[104:105], v147 offset:40960
    ds_read_b64_tr_b16 v[106:107], v147 offset:41280
    v_mfma_f32_32x32x16_bf16 v[48:63], v[112:115], a[124:127], v[48:63]
    s_waitcnt lgkmcnt(4)
    v_mfma_f32_32x32x16_bf16 v[32:47], v[116:119], a[128:131], v[32:47]
    s_mov_b32 s67, 0
    s_add_u32 m0, s18, 1024
    s_nop 0
    buffer_load_dwordx4 v23, s[36:39], s67 offen lds
    ds_read_b64_tr_b16 v[108:109], v144 offset:40960
    ds_read_b64_tr_b16 v[110:111], v144 offset:41280
    ds_read_b64_tr_b16 v[112:113], v148 offset:40960
    ds_read_b64_tr_b16 v[114:115], v148 offset:41280
    v_mfma_f32_32x32x16_bf16 v[48:63], v[120:123], a[128:131], v[48:63]
    v_mfma_f32_4x4x4_16b_bf16 v[88:91], v[136:137], v[116:117], v[88:91]
    v_mfma_f32_4x4x4_16b_bf16 v[92:95], v[136:137], v[120:121], v[92:95]
    s_nop 0
    v_mfma_f32_4x4x4_16b_bf16 v[88:91], v[136:137], v[118:119], v[88:91]
    v_mfma_f32_4x4x4_16b_bf16 v[92:95], v[136:137], v[122:123], v[92:95]
    s_waitcnt lgkmcnt(4)
    v_mfma_f32_32x32x16_bf16 v[32:47], v[100:103], a[132:135], v[32:47]
    ds_read_b64_tr_b16 v[116:117], v145 offset:40960
    ds_read_b64_tr_b16 v[118:119], v145 offset:41280
    ds_read_b64_tr_b16 v[120:121], v149 offset:40960
    s_mov_b32 s67, 0
    s_add_u32 m0, s18, 2048
    s_nop 0
    buffer_load_dwordx4 v24, s[36:39], s67 offen lds
    ds_read_b64_tr_b16 v[122:123], v149 offset:41280
    v_mfma_f32_32x32x16_bf16 v[48:63], v[104:107], a[132:135], v[48:63]
    s_waitcnt lgkmcnt(4)
    v_mfma_f32_32x32x16_bf16 v[32:47], v[108:111], a[136:139], v[32:47]
    ds_read_b64_tr_b16 v[100:101], v142 offset:46080
    ds_read_b64_tr_b16 v[102:103], v142 offset:46400
    ds_read_b64_tr_b16 v[104:105], v146 offset:46080
    ds_read_b64_tr_b16 v[106:107], v146 offset:46400
    v_mfma_f32_32x32x16_bf16 v[48:63], v[112:115], a[136:139], v[48:63]
    s_waitcnt lgkmcnt(4)
    v_mfma_f32_32x32x16_bf16 v[32:47], v[116:119], a[140:143], v[32:47]
    s_mov_b32 s67, 196608
    s_add_u32 m0, s18, 12288
    s_nop 0
    buffer_load_dwordx4 v22, s[36:39], s67 offen lds
    ds_read_b64_tr_b16 v[108:109], v143 offset:46080
    ds_read_b64_tr_b16 v[110:111], v143 offset:46400
    ds_read_b64_tr_b16 v[112:113], v147 offset:46080
    ds_read_b64_tr_b16 v[114:115], v147 offset:46400
    v_mfma_f32_32x32x16_bf16 v[48:63], v[120:123], a[140:143], v[48:63]
    s_waitcnt lgkmcnt(4)
    v_mfma_f32_32x32x16_bf16 v[32:47], v[100:103], a[144:147], v[32:47]
    ds_read_b64_tr_b16 v[116:117], v144 offset:46080
    ds_read_b64_tr_b16 v[118:119], v144 offset:46400
    ds_read_b64_tr_b16 v[120:121], v148 offset:46080
    ds_read_b64_tr_b16 v[122:123], v148 offset:46400
    s_mov_b32 s67, 196608
    s_add_u32 m0, s18, 13312
    s_nop 0
    buffer_load_dwordx4 v23, s[36:39], s67 offen lds
    v_mfma_f32_32x32x16_bf16 v[48:63], v[104:107], a[144:147], v[48:63]
    v_mfma_f32_4x4x4_16b_bf16 v[88:91], v[136:137], v[100:101], v[88:91]
    v_mfma_f32_4x4x4_16b_bf16 v[92:95], v[136:137], v[104:105], v[92:95]
    s_nop 0
    v_mfma_f32_4x4x4_16b_bf16 v[88:91], v[136:137], v[102:103], v[88:91]
    v_mfma_f32_4x4x4_16b_bf16 v[92:95], v[136:137], v[106:107], v[92:95]
    s_waitcnt vmcnt(6)
    v_mov_b32 v161, 1
    s_mov_b64 exec, 1
    buffer_atomic_add v161, v197, s[48:51], 0 offen sc1
    s_mov_b64 exec, -1
    s_waitcnt lgkmcnt(4)
    v_mfma_f32_32x32x16_bf16 v[32:47], v[108:111], a[148:151], v[32:47]
    ds_read_b64_tr_b16 v[100:101], v145 offset:46080
    ds_read_b64_tr_b16 v[102:103], v145 offset:46400
    ds_read_b64_tr_b16 v[104:105], v149 offset:46080
    ds_read_b64_tr_b16 v[106:107], v149 offset:46400
    v_mov_b32 v89, v88
    s_nop 1
    v_permlane32_swap_b32 v88, v89
    v_add_f32 v88, v88, v89
    v_mov_b32 v93, v92
    s_nop 1
    v_permlane32_swap_b32 v92, v93
    v_add_f32 v92, v92, v93
    v_mfma_f32_32x32x16_bf16 v[48:63], v[112:115], a[148:151], v[48:63]
    s_mov_b32 s67, 196608
    s_add_u32 m0, s18, 14336
    s_nop 0
    buffer_load_dwordx4 v24, s[36:39], s67 offen lds
    v_mov_b32 v89, v92
    ds_write_b128 v152, v[88:91]
    s_waitcnt lgkmcnt(0)
    s_barrier
    v_mfma_f32_32x32x16_bf16 v[32:47], v[116:119], a[152:155], v[32:47]
    ds_read_b128 v[64:67], v153 offset:0
    ds_read_b128 v[68:71], v153 offset:512
    v_mfma_f32_32x32x16_bf16 v[48:63], v[120:123], a[152:155], v[48:63]
    ds_read_b128 v[72:75], v153 offset:1024
    ds_read_b128 v[76:79], v153 offset:1536
    v_mfma_f32_32x32x16_bf16 v[32:47], v[100:103], a[156:159], v[32:47]
    s_mov_b32 s67, 393216
    s_add_u32 m0, s18, 24576
    s_nop 0
    buffer_load_dwordx4 v22, s[36:39], s67 offen lds
    s_waitcnt lgkmcnt(0)
    v_pk_add_f32 v[64:65], v[64:65], v[68:69]
    v_pk_add_f32 v[72:73], v[72:73], v[76:77]
    v_mfma_f32_32x32x16_bf16 v[48:63], v[104:107], a[156:159], v[48:63]
    v_pk_add_f32 v[64:65], v[64:65], v[72:73]
    ds_write_b32 v154, v64 offset:0
    ds_write_b32 v154, v65 offset:128
    ds_read_b128 v[64:67], v155 offset:0
    ds_read_b128 v[68:71], v155 offset:32
    ds_read_b128 v[72:75], v155 offset:64
    ds_read_b128 v[76:79], v155 offset:96
    ds_read_b128 v[80:83], v155 offset:128
    s_mov_b32 s66, 0
    s_branch L_pollchk_8
L_poll_6:
    s_mov_b32 s62, 0
    s_atomic_add s62, s[32:33], s17 glc
L_pollchk_8:
    s_add_u32 s66, s66, 1
    s_cmp_ge_u32 s66, 40000
    s_waitcnt lgkmcnt(0)
    s_cbranch_scc1 L_polled_7
    s_cmp_lt_u32 s62, 16
    s_cbranch_scc1 L_poll_6
L_polled_7:
    s_mov_b32 s62, 0
    s_atomic_add s62, s[32:33], s15 glc
    s_mov_b32 s63, 0
    s_atomic_add s63, s[32:33], s16 glc
    buffer_load_dwordx4 v[164:167], v1, s[32:35], s12 offen sc1
    s_add_u32 s12, s12, 4096
    buffer_load_dwordx4 v[168:171], v1, s[32:35], s12 offen sc1
    s_add_u32 s12, s12, 4096
    buffer_load_dwordx4 v[172:175], v1, s[32:35], s12 offen sc1
    s_add_u32 s12, s12, 4096
    buffer_load_dwordx4 v[176:179], v1, s[32:35], s12 offen sc1
    s_add_u32 s12, s12, 4096
    v_pk_fma_f32 v[32:33], v[64:65], v[150:151], v[32:33] op_sel_hi:[1,0,1]
    buffer_load_dwordx4 v[180:183], v1, s[32:35], s12 offen sc1
    s_add_u32 s12, s12, 4096
    v_pk_fma_f32 v[34:35], v[66:67], v[150:151], v[34:35] op_sel_hi:[1,0,1]
    buffer_load_dwordx4 v[184:187], v1, s[32:35], s12 offen sc1
    s_add_u32 s12, s12, 4096
    v_pk_fma_f32 v[36:37], v[68:69], v[150:151], v[36:37] op_sel_hi:[1,0,1]
    v_pk_fma_f32 v[38:39], v[70:71], v[150:151], v[38:39] op_sel_hi:[1,0,1]
    v_pk_fma_f32 v[40:41], v[72:73], v[150:151], v[40:41] op_sel_hi:[1,0,1]
    v_pk_fma_f32 v[42:43], v[74:75], v[150:151], v[42:43] op_sel_hi:[1,0,1]
    v_pk_fma_f32 v[44:45], v[76:77], v[150:151], v[44:45] op_sel_hi:[1,0,1]
    v_pk_fma_f32 v[46:47], v[78:79], v[150:151], v[46:47] op_sel_hi:[1,0,1]
    v_pk_fma_f32 v[48:49], v[80:81], v[150:151], v[48:49] op_sel_hi:[1,0,1]
    v_pk_fma_f32 v[50:51], v[82:83], v[150:151], v[50:51] op_sel_hi:[1,0,1]
    v_cvt_pk_bf16_f32 v100, v32, v33
    v_cvt_pk_bf16_f32 v101, v34, v35
    v_cvt_pk_bf16_f32 v102, v36, v37
    v_cvt_pk_bf16_f32 v103, v38, v39
    v_cvt_pk_bf16_f32 v104, v40, v41
    v_cvt_pk_bf16_f32 v105, v42, v43
    v_cvt_pk_bf16_f32 v106, v44, v45
    buffer_load_dwordx4 v[188:191], v1, s[32:35], s12 offen sc1
    s_add_u32 s12, s12, 4096
    v_cvt_pk_bf16_f32 v107, v46, v47
    v_cvt_pk_bf16_f32 v108, v48, v49
    v_cvt_pk_bf16_f32 v109, v50, v51
    v_mov_b32 v110, 0
    v_mov_b32 v111, 0
    v_mov_b32 v31, 0x3f80
    s_lshl_b32 s13, s3, 10
    s_add_u32 s13, s13, 131072
    v_mfma_f32_32x32x16_bf16 v[64:79], v[232:235], v[100:103], 0
    buffer_load_dwordx4 v[192:195], v1, s[32:35], s12 offen sc1
    s_add_u32 s12, s12, 4096
    v_lshrrev_b32 v25, 5, v0
    v_bfe_u32 v26, v0, 2, 1
    v_cmp_eq_u32 vcc, v25, v26
    v_bfe_u32 v26, v0, 3, 2
    v_and_b32 v27, 3, v0
    v_lshl_add_u32 v26, v26, 2, v27
    v_lshlrev_b32 v25, 11, v25
    v_mfma_f32_32x32x16_bf16 v[80:95], v[244:247], v[100:103], 0
    v_add_u32 v25, 131072, v25
    buffer_load_dwordx4 v[196:199], v1, s[32:35], s12 offen sc1
    s_add_u32 s12, s12, 4096
    v_lshl_add_u32 v27, v26, 4, v25
    v_lshl_add_u32 v28, v26, 3, v25
    v_add_u32 v28, 768, v28
    v_mov_b32 v29, 159360
    v_cndmask_b32 v14, v29, v27, vcc
    v_cndmask_b32 v15, v29, v28, vcc
    v_mfma_f32_32x32x16_bf16 v[64:79], v[236:239], v[104:107], v[64:79]
    v_and_b32 v27, 1, v0
    v_lshlrev_b32 v27, 4, v27
    buffer_load_dwordx4 v[200:203], v1, s[32:35], s12 offen sc1
    s_add_u32 s12, s12, 4096
    v_lshlrev_b32 v27, v27, v31
    v_cndmask_b32 v27, 0, v27, vcc
    v_bfe_u32 v28, v0, 3, 2
    v_bfe_u32 v29, v0, 1, 1
    v_lshl_add_u32 v28, v28, 1, v29
    v_mfma_f32_32x32x16_bf16 v[80:95], v[248:251], v[104:107], v[80:95]
    v_cmp_eq_u32 vcc, 0, v28
    s_nop 1
    v_cndmask_b32 v16, 0, v27, vcc
    v_cmp_eq_u32 vcc, 1, v28
    buffer_load_dwordx4 v[204:207], v1, s[32:35], s12 offen sc1
    s_add_u32 s12, s12, 4096
    v_cndmask_b32 v17, 0, v27, vcc
    v_cmp_eq_u32 vcc, 2, v28
    s_nop 1
    v_cndmask_b32 v18, 0, v27, vcc
    v_cmp_eq_u32 vcc, 3, v28
    v_mfma_f32_32x32x16_bf16 v[64:79], v[240:243], v[108:111], v[64:79]
    s_nop 0
    v_cndmask_b32 v19, 0, v27, vcc
    v_add_u32 v30, s13, v1
    v_bfe_u32 v25, v0, 4, 1
    v_lshl_add_u32 v25, s3, 1, v25
    buffer_load_dwordx4 v[208:211], v1, s[32:35], s12 offen sc1
    s_add_u32 s12, s12, 4096
    v_mul_u32_u24 v25, 20480, v25
    v_and_b32 v26, 15, v0
    v_lshl_add_u32 v25, v26, 4, v25
    v_mfma_f32_32x32x16_bf16 v[80:95], v[252:255], v[108:111], v[80:95]
    v_lshrrev_b32 v27, 5, v0
    v_lshl_add_u32 v26, v27, 9, v25
    v_lshl_add_u32 v27, v27, 3, v25
    s_mov_b32 s66, 0
    s_branch L_pollchk_11
L_poll_9:
    s_mov_b32 s62, 0
    s_atomic_add s62, s[32:33], s15 glc
    s_mov_b32 s63, 0
    s_atomic_add s63, s[32:33], s16 glc
L_pollchk_11:
    s_add_u32 s66, s66, 1
    s_cmp_ge_u32 s66, 40000
    s_waitcnt lgkmcnt(0)
    s_cbranch_scc1 L_polled_10
    s_cmp_lt_u32 s62, 5
    s_cbranch_scc1 L_poll_9
    s_cmp_lt_u32 s63, 12
    s_cbranch_scc1 L_poll_9
L_polled_10:
    v_max3_f32 v96, v64, v65, v66
    v_min3_f32 v98, v64, v65, v66
    buffer_load_dwordx4 v[212:215], v1, s[32:35], s12 offen sc1
    s_add_u32 s12, s12, 4096
    v_max3_f32 v96, v96, v67, v68
    v_min3_f32 v98, v98, v67, v68
    v_max3_f32 v96, v96, v69, v70
    v_min3_f32 v98, v98, v69, v70
    v_max3_f32 v96, v96, v71, v72
    v_min3_f32 v98, v98, v71, v72
    v_max3_f32 v96, v96, v73, v74
    v_min3_f32 v98, v98, v73, v74
    v_max3_f32 v96, v96, v75, v76
    v_min3_f32 v98, v98, v75, v76
    v_max3_f32 v96, v96, v77, v78
    v_min3_f32 v98, v98, v77, v78
    v_max3_f32 v96, v96, v79, v80
    v_min3_f32 v98, v98, v79, v80
    v_max3_f32 v96, v96, v81, v82
    v_min3_f32 v98, v98, v81, v82
    buffer_load_dwordx4 v[216:219], v1, s[32:35], s12 offen sc1
    s_add_u32 s12, s12, 4096
    v_max_f32 v96, v96, v83
    v_min_f32 v98, v98, v83
    v_mul_f32 v96, v96, -v160
    v_mul_f32 v98, v98, v160
    v_pk_fma_f32 v[32:33], v[64:65], v[160:161], v[96:97] op_sel_hi:[1,0,0]
    v_pk_fma_f32 v[34:35], v[66:67], v[160:161], v[96:97] op_sel_hi:[1,0,0]
    v_pk_fma_f32 v[36:37], v[68:69], v[160:161], v[96:97] op_sel_hi:[1,0,0]
    v_pk_fma_f32 v[38:39], v[70:71], v[160:161], v[96:97] op_sel_hi:[1,0,0]
    v_pk_fma_f32 v[40:41], v[72:73], v[160:161], v[96:97] op_sel_hi:[1,0,0]
    v_pk_fma_f32 v[42:43], v[74:75], v[160:161], v[96:97] op_sel_hi:[1,0,0]
    v_pk_fma_f32 v[44:45], v[76:77], v[160:161], v[96:97] op_sel_hi:[1,0,0]
    v_pk_fma_f32 v[46:47], v[78:79], v[160:161], v[96:97] op_sel_hi:[1,0,0]
    v_pk_fma_f32 v[48:49], v[80:81], v[160:161], v[96:97] op_sel_hi:[1,0,0]
    v_pk_fma_f32 v[50:51], v[82:83], v[160:161], v[96:97] op_sel_hi:[1,0,0]
    v_exp_f32 v32, v32
    buffer_load_dwordx4 v[220:223], v1, s[32:35], s12 offen sc1
    s_add_u32 s12, s12, 4096
    v_pk_fma_f32 v[104:105], v[64:65], v[160:161], v[98:99] op_sel_hi:[1,0,0] neg_lo:[1,0,0] neg_hi:[1,0,0]
    v_exp_f32 v33, v33
    v_exp_f32 v34, v34
    v_pk_fma_f32 v[106:107], v[66:67], v[160:161], v[98:99] op_sel_hi:[1,0,0] neg_lo:[1,0,0] neg_hi:[1,0,0]
    v_exp_f32 v35, v35
    v_exp_f32 v36, v36
    v_pk_fma_f32 v[108:109], v[68:69], v[160:161], v[98:99] op_sel_hi:[1,0,0] neg_lo:[1,0,0] neg_hi:[1,0,0]
    v_exp_f32 v37, v37
    v_exp_f32 v38, v38
    v_pk_fma_f32 v[110:111], v[70:71], v[160:161], v[98:99] op_sel_hi:[1,0,0] neg_lo:[1,0,0] neg_hi:[1,0,0]
    buffer_load_dwordx4 v[224:227], v1, s[32:35], s12 offen sc1
    v_exp_f32 v39, v39
    v_exp_f32 v40, v40
    v_pk_fma_f32 v[112:113], v[72:73], v[160:161], v[98:99] op_sel_hi:[1,0,0] neg_lo:[1,0,0] neg_hi:[1,0,0]
    v_exp_f32 v41, v41
    v_exp_f32 v42, v42
    v_pk_fma_f32 v[114:115], v[74:75], v[160:161], v[98:99] op_sel_hi:[1,0,0] neg_lo:[1,0,0] neg_hi:[1,0,0]
    v_exp_f32 v43, v43
    v_exp_f32 v44, v44
    v_pk_fma_f32 v[116:117], v[76:77], v[160:161], v[98:99] op_sel_hi:[1,0,0] neg_lo:[1,0,0] neg_hi:[1,0,0]
    v_exp_f32 v45, v45
    s_mov_b32 s67, 393216
    s_add_u32 m0, s18, 25600
    s_nop 0
    buffer_load_dwordx4 v23, s[36:39], s67 offen lds
    v_exp_f32 v46, v46
    v_pk_fma_f32 v[118:119], v[78:79], v[160:161], v[98:99] op_sel_hi:[1,0,0] neg_lo:[1,0,0] neg_hi:[1,0,0]
    v_exp_f32 v47, v47
    v_exp_f32 v48, v48
    v_pk_fma_f32 v[120:121], v[80:81], v[160:161], v[98:99] op_sel_hi:[1,0,0] neg_lo:[1,0,0] neg_hi:[1,0,0]
    v_exp_f32 v49, v49
    v_exp_f32 v50, v50
    v_pk_fma_f32 v[122:123], v[82:83], v[160:161], v[98:99] op_sel_hi:[1,0,0] neg_lo:[1,0,0] neg_hi:[1,0,0]
    v_exp_f32 v51, v51
    s_mov_b32 s67, 393216
    s_add_u32 m0, s18, 26624
    s_nop 0
    buffer_load_dwordx4 v24, s[36:39], s67 offen lds
    v_exp_f32 v104, v104
    s_waitcnt vmcnt(17)
    v_mfma_f32_32x32x16_bf16 v[144:159], v[16:19], v[164:167], 0
    v_exp_f32 v105, v105
    v_exp_f32 v106, v106
    v_pk_add_f32 v[100:101], v[32:33], v[34:35]
    v_exp_f32 v107, v107
    v_exp_f32 v108, v108
    s_waitcnt vmcnt(16)
    v_mfma_f32_32x32x16_bf16 v[144:159], v[16:19], v[168:171], v[144:159]
    v_pk_add_f32 v[100:101], v[100:101], v[36:37]
    v_exp_f32 v109, v109
    v_exp_f32 v110, v110
    s_mov_b32 s67, 589824
    s_add_u32 m0, s18, 36864
    s_nop 0
    buffer_load_dwordx4 v22, s[36:39], s67 offen lds
    v_pk_add_f32 v[100:101], v[100:101], v[38:39]
    v_exp_f32 v111, v111
    s_waitcnt vmcnt(16)
    v_mfma_f32_32x32x16_bf16 v[144:159], v[16:19], v[172:175], v[144:159]
    v_exp_f32 v112, v112
    v_pk_add_f32 v[100:101], v[100:101], v[40:41]
    v_exp_f32 v113, v113
    v_exp_f32 v114, v114
    v_pk_add_f32 v[100:101], v[100:101], v[42:43]
    s_waitcnt vmcnt(15)
    v_mfma_f32_32x32x16_bf16 v[144:159], v[16:19], v[176:179], v[144:159]
    v_exp_f32 v115, v115
    v_exp_f32 v116, v116
    v_pk_add_f32 v[100:101], v[100:101], v[44:45]
    s_mov_b32 s67, 589824
    s_add_u32 m0, s18, 37888
    s_nop 0
    buffer_load_dwordx4 v23, s[36:39], s67 offen lds
    v_exp_f32 v117, v117
    v_exp_f32 v118, v118
    s_waitcnt vmcnt(15)
    v_mfma_f32_32x32x16_bf16 v[144:159], v[16:19], v[180:183], v[144:159]
    v_pk_add_f32 v[100:101], v[100:101], v[46:47]
    v_exp_f32 v119, v119
    v_exp_f32 v120, v120
    v_pk_add_f32 v[100:101], v[100:101], v[48:49]
    v_exp_f32 v121, v121
    s_waitcnt vmcnt(14)
    v_mfma_f32_32x32x16_bf16 v[144:159], v[16:19], v[184:187], v[144:159]
    v_exp_f32 v122, v122
    v_pk_add_f32 v[100:101], v[100:101], v[50:51]
    v_exp_f32 v123, v123
    s_mov_b32 s67, 589824
    s_add_u32 m0, s18, 38912
    s_nop 0
    buffer_load_dwordx4 v24, s[36:39], s67 offen lds
    v_add_f32 v100, v100, v101
    v_pk_add_f32 v[102:103], v[104:105], v[106:107]
    v_rcp_f32 v100, v100
    s_waitcnt vmcnt(14)
    v_mfma_f32_32x32x16_bf16 v[144:159], v[16:19], v[188:191], v[144:159]
    v_pk_add_f32 v[102:103], v[102:103], v[108:109]
    v_pk_add_f32 v[102:103], v[102:103], v[110:111]
    v_pk_add_f32 v[102:103], v[102:103], v[112:113]
    v_pk_add_f32 v[102:103], v[102:103], v[114:115]
    v_pk_add_f32 v[102:103], v[102:103], v[116:117]
    v_pk_add_f32 v[102:103], v[102:103], v[118:119]
    v_pk_add_f32 v[102:103], v[102:103], v[120:121]
    v_pk_add_f32 v[102:103], v[102:103], v[122:123]
    s_waitcnt vmcnt(13)
    v_mfma_f32_32x32x16_bf16 v[144:159], v[16:19], v[192:195], v[144:159]
    v_add_f32 v102, v102, v103
    v_rcp_f32 v102, v102
    buffer_load_dwordx4 v[4:7], v2, s[24:27], 0 offen offset:0
    v_pk_mul_f32 v[32:33], v[32:33], v[100:101] op_sel_hi:[1,0]
    v_pk_mul_f32 v[34:35], v[34:35], v[100:101] op_sel_hi:[1,0]
    v_pk_mul_f32 v[36:37], v[36:37], v[100:101] op_sel_hi:[1,0]
    v_pk_mul_f32 v[38:39], v[38:39], v[100:101] op_sel_hi:[1,0]
    v_pk_mul_f32 v[40:41], v[40:41], v[100:101] op_sel_hi:[1,0]
    s_waitcnt vmcnt(13)
    v_mfma_f32_32x32x16_bf16 v[144:159], v[16:19], v[196:199], v[144:159]
    v_pk_mul_f32 v[42:43], v[42:43], v[100:101] op_sel_hi:[1,0]
    v_pk_mul_f32 v[44:45], v[44:45], v[100:101] op_sel_hi:[1,0]
    v_pk_mul_f32 v[46:47], v[46:47], v[100:101] op_sel_hi:[1,0]
    v_pk_mul_f32 v[48:49], v[48:49], v[100:101] op_sel_hi:[1,0]
    v_pk_mul_f32 v[50:51], v[50:51], v[100:101] op_sel_hi:[1,0]
    v_cvt_pk_bf16_f32 v124, v32, v33
    v_cvt_pk_bf16_f32 v125, v34, v35
    v_cvt_pk_bf16_f32 v126, v40, v41
    s_waitcnt vmcnt(12)
    v_mfma_f32_32x32x16_bf16 v[144:159], v[16:19], v[200:203], v[144:159]
    v_cvt_pk_bf16_f32 v127, v42, v43
    v_cvt_pk_bf16_f32 v128, v36, v37
    v_cvt_pk_bf16_f32 v129, v38, v39
    buffer_load_dwordx4 v[8:11], v2, s[24:27], 0 offen offset:16
    v_cvt_pk_bf16_f32 v130, v44, v45
    v_cvt_pk_bf16_f32 v131, v46, v47
    v_cvt_pk_bf16_f32 v140, v48, v49
    v_cvt_pk_bf16_f32 v141, v50, v51
    v_pk_mul_f32 v[104:105], v[104:105], v[102:103] op_sel_hi:[1,0]
    s_waitcnt vmcnt(12)
    v_mfma_f32_32x32x16_bf16 v[144:159], v[16:19], v[204:207], v[144:159]
    v_pk_mul_f32 v[106:107], v[106:107], v[102:103] op_sel_hi:[1,0]
    v_pk_mul_f32 v[108:109], v[108:109], v[102:103] op_sel_hi:[1,0]
    v_pk_mul_f32 v[110:111], v[110:111], v[102:103] op_sel_hi:[1,0]
    v_pk_mul_f32 v[112:113], v[112:113], v[102:103] op_sel_hi:[1,0]
    v_pk_mul_f32 v[114:115], v[114:115], v[102:103] op_sel_hi:[1,0]
    v_pk_mul_f32 v[116:117], v[116:117], v[102:103] op_sel_hi:[1,0]
    v_pk_mul_f32 v[118:119], v[118:119], v[102:103] op_sel_hi:[1,0]
    v_pk_mul_f32 v[120:121], v[120:121], v[102:103] op_sel_hi:[1,0]
    s_waitcnt vmcnt(11)
    v_mfma_f32_32x32x16_bf16 v[144:159], v[16:19], v[208:211], v[144:159]
    v_pk_mul_f32 v[122:123], v[122:123], v[102:103] op_sel_hi:[1,0]
    v_cvt_pk_bf16_f32 v132, v104, v105
    v_cvt_pk_bf16_f32 v133, v106, v107
    buffer_load_dwordx2 v[12:13], v2, s[24:27], 0 offen offset:32
    v_cvt_pk_bf16_f32 v134, v112, v113
    v_cvt_pk_bf16_f32 v135, v114, v115
    v_cvt_pk_bf16_f32 v136, v108, v109
    v_cvt_pk_bf16_f32 v137, v110, v111
    v_cvt_pk_bf16_f32 v138, v116, v117
    s_waitcnt vmcnt(11)
    v_mfma_f32_32x32x16_bf16 v[144:159], v[16:19], v[212:215], v[144:159]
    v_cvt_pk_bf16_f32 v139, v118, v119
    v_cvt_pk_bf16_f32 v142, v120, v121
    v_cvt_pk_bf16_f32 v143, v122, v123
    s_waitcnt vmcnt(10)
    v_mfma_f32_32x32x16_bf16 v[144:159], v[16:19], v[216:219], v[144:159]
    s_waitcnt vmcnt(9)
    v_mfma_f32_32x32x16_bf16 v[144:159], v[16:19], v[220:223], v[144:159]
    s_waitcnt vmcnt(8)
    v_mfma_f32_32x32x16_bf16 v[144:159], v[16:19], v[224:227], v[144:159]
    s_nop 11
    v_cvt_pk_bf16_f32 v72, v144, v145
    v_cvt_pk_bf16_f32 v73, v146, v147
    v_cvt_pk_bf16_f32 v74, v148, v149
    v_cvt_pk_bf16_f32 v75, v150, v151
    ds_write_b128 v30, v[72:75]
    s_mul_i32 s12, s4, 163840
    s_mul_i32 s13, s5, 1280
    s_add_u32 s12, s12, s13
    s_add_u32 s12, s12, 2097152
    s_lshr_b32 s13, s3, 1
    s_lshl1_add_u32 s13, s4, s13
    s_lshr_b32 s14, s5, 2
    s_lshl2_add_u32 s13, s13, s14
    s_add_u32 s13, s13, 64
    s_lshl_b32 s13, s13, 7
    s_waitcnt lgkmcnt(0)
    s_barrier
    ds_read_b128 v[184:187], v14 offset:256
    buffer_load_dwordx4 a[156:159], v1, s[32:35], s19 offen offset:0 sc1
    ds_read_b128 v[188:191], v14 offset:640
    ds_read_b128 v[192:195], v14 offset:1280
    ds_read_b128 v[196:199], v14 offset:1664
    ds_read_b64 v[200:201], v15 offset:128
    ds_read_b64 v[202:203], v15 offset:1152
    ds_read_b128 v[164:167], v14 offset:0
    buffer_load_dwordx4 a[160:163], v1, s[32:35], s19 offen offset:1024 sc1
    ds_read_b128 v[168:171], v14 offset:384
    ds_read_b128 v[172:175], v14 offset:1024
    ds_read_b128 v[176:179], v14 offset:1408
    ds_read_b64 v[180:181], v15 offset:0
    ds_read_b64 v[182:183], v15 offset:1024
    s_waitcnt lgkmcnt(11)
    v_mfma_f32_32x32x16_bf16 v[48:63], v[184:187], v[124:127], 0
    s_waitcnt lgkmcnt(10)
    v_mfma_f32_32x32x16_bf16 v[48:63], v[188:191], v[128:131], v[48:63]
    buffer_load_dwordx4 a[164:167], v1, s[32:35], s19 offen offset:2048 sc1
    s_waitcnt lgkmcnt(9)
    v_mfma_f32_32x32x16_bf16 v[48:63], v[192:195], v[132:135], v[48:63]
    buffer_load_dwordx4 a[168:171], v1, s[32:35], s19 offen offset:3072 sc1
    s_add_u32 s19, s19, 4096
    s_waitcnt lgkmcnt(8)
    v_mfma_f32_32x32x16_bf16 v[48:63], v[196:199], v[136:139], v[48:63]
    s_waitcnt lgkmcnt(6)
    v_mfma_f32_32x32x16_bf16 v[48:63], v[200:203], v[140:143], v[48:63]
    buffer_load_dwordx4 a[172:175], v1, s[32:35], s19 offen offset:0 sc1
    s_waitcnt lgkmcnt(5)
    v_mfma_f32_32x32x16_bf16 v[32:47], v[164:167], v[124:127], 0
    s_waitcnt lgkmcnt(4)
    v_mfma_f32_32x32x16_bf16 v[32:47], v[168:171], v[128:131], v[32:47]
    buffer_load_dwordx4 a[176:179], v1, s[32:35], s19 offen offset:1024 sc1
    s_waitcnt lgkmcnt(3)
    v_mfma_f32_32x32x16_bf16 v[32:47], v[172:175], v[132:135], v[32:47]
    s_waitcnt lgkmcnt(2)
    v_mfma_f32_32x32x16_bf16 v[32:47], v[176:179], v[136:139], v[32:47]
    buffer_load_dwordx4 a[180:183], v1, s[32:35], s19 offen offset:2048 sc1
    s_waitcnt lgkmcnt(0)
    v_mfma_f32_32x32x16_bf16 v[32:47], v[180:183], v[140:143], v[32:47]
    v_add_f32 v54, 0x358637bd, v52
    buffer_load_dwordx4 a[184:187], v1, s[32:35], s19 offen offset:3072 sc1
    s_add_u32 s19, s19, 4096
    v_rcp_f32 v54, v54
    s_nop 0
    v_pk_mul_f32 v[48:49], v[48:49], v[54:55] op_sel_hi:[1,0]
    v_pk_mul_f32 v[50:51], v[50:51], v[54:55] op_sel_hi:[1,0]
    s_nop 4
    v_pk_mul_f32 v[32:33], v[32:33], v[54:55] op_sel_hi:[1,0]
    v_pk_mul_f32 v[34:35], v[34:35], v[54:55] op_sel_hi:[1,0]
    v_pk_mul_f32 v[36:37], v[36:37], v[54:55] op_sel_hi:[1,0]
    v_pk_mul_f32 v[38:39], v[38:39], v[54:55] op_sel_hi:[1,0]
    v_pk_mul_f32 v[40:41], v[40:41], v[54:55] op_sel_hi:[1,0]
    v_pk_mul_f32 v[42:43], v[42:43], v[54:55] op_sel_hi:[1,0]
    v_pk_mul_f32 v[44:45], v[44:45], v[54:55] op_sel_hi:[1,0]
    v_pk_mul_f32 v[46:47], v[46:47], v[54:55] op_sel_hi:[1,0]
    v_cvt_pk_bf16_f32 v64, v32, v33
    v_cvt_pk_bf16_f32 v65, v34, v35
    v_cvt_pk_bf16_f32 v66, v36, v37
    v_cvt_pk_bf16_f32 v67, v38, v39
    buffer_load_dwordx4 a[188:191], v1, s[32:35], s19 offen offset:0 sc1
    v_cvt_pk_bf16_f32 v68, v40, v41
    v_cvt_pk_bf16_f32 v69, v42, v43
    v_cvt_pk_bf16_f32 v70, v44, v45
    v_cvt_pk_bf16_f32 v71, v46, v47
    v_cvt_pk_bf16_f32 v72, v48, v49
    v_cvt_pk_bf16_f32 v73, v50, v51
    buffer_store_dwordx4 v[64:67], v26, s[32:35], s12 offen sc1
    buffer_store_dwordx4 v[68:71], v26, s[32:35], s12 offen offset:256 sc1
    buffer_store_dwordx2 v[72:73], v27, s[32:35], s12 offen offset:1024 sc1
    v_lshrrev_b32 v25, 5, v0
    v_bfe_u32 v28, v0, 2, 2
    v_lshl_add_u32 v25, v25, 3, v28
    v_mul_u32_u24 v25, 192, v25
    v_bfe_u32 v28, v0, 4, 1
    v_and_b32 v29, 3, v0
    buffer_load_dwordx4 a[192:195], v1, s[32:35], s19 offen offset:1024 sc1
    v_lshl_add_u32 v28, v28, 2, v29
    v_lshl_add_u32 v25, v28, 3, v25
    s_mul_i32 s14, s3, 24576
    v_add_u32 v146, s14, v25
    v_mov_b32 v144, 0x3f803f80
    v_mov_b32 v145, 0x3f803f80
    ds_read_b64_tr_b16 v[76:77], v146 offset:0
    ds_read_b64_tr_b16 v[78:79], v146 offset:768
    ds_read_b64_tr_b16 v[80:81], v146 offset:64
    ds_read_b64_tr_b16 v[82:83], v146 offset:832
    ds_read_b64_tr_b16 v[84:85], v146 offset:128
    ds_read_b64_tr_b16 v[86:87], v146 offset:896
    buffer_load_dwordx4 a[196:199], v1, s[32:35], s19 offen offset:2048 sc1
    ds_read_b64_tr_b16 v[88:89], v146 offset:3072
    ds_read_b64_tr_b16 v[90:91], v146 offset:3840
    ds_read_b64_tr_b16 v[92:93], v146 offset:3136
    ds_read_b64_tr_b16 v[94:95], v146 offset:3904
    ds_read_b64_tr_b16 v[96:97], v146 offset:3200
    ds_read_b64_tr_b16 v[98:99], v146 offset:3968
    s_waitcnt lgkmcnt(6)
    v_mfma_f32_4x4x4_16b_bf16 v[132:135], v[144:145], v[76:77], 0
    v_mfma_f32_4x4x4_16b_bf16 v[136:139], v[144:145], v[80:81], 0
    v_mfma_f32_4x4x4_16b_bf16 v[140:143], v[144:145], v[84:85], 0
    v_mfma_f32_4x4x4_16b_bf16 v[132:135], v[144:145], v[78:79], v[132:135]
    v_mfma_f32_4x4x4_16b_bf16 v[136:139], v[144:145], v[82:83], v[136:139]
    v_mfma_f32_4x4x4_16b_bf16 v[140:143], v[144:145], v[86:87], v[140:143]
    ds_read_b64_tr_b16 v[100:101], v146 offset:6144
    ds_read_b64_tr_b16 v[102:103], v146 offset:6912
    ds_read_b64_tr_b16 v[104:105], v146 offset:6208
    ds_read_b64_tr_b16 v[106:107], v146 offset:6976
    ds_read_b64_tr_b16 v[108:109], v146 offset:6272
    buffer_load_dwordx4 a[200:203], v1, s[32:35], s19 offen offset:3072 sc1
    s_add_u32 s19, s19, 4096
    ds_read_b64_tr_b16 v[110:111], v146 offset:7040
    s_waitcnt lgkmcnt(6)
    v_mfma_f32_4x4x4_16b_bf16 v[132:135], v[144:145], v[88:89], v[132:135]
    v_mfma_f32_4x4x4_16b_bf16 v[136:139], v[144:145], v[92:93], v[136:139]
    v_mfma_f32_4x4x4_16b_bf16 v[140:143], v[144:145], v[96:97], v[140:143]
    v_mfma_f32_4x4x4_16b_bf16 v[132:135], v[144:145], v[90:91], v[132:135]
    v_mfma_f32_4x4x4_16b_bf16 v[136:139], v[144:145], v[94:95], v[136:139]
    v_mfma_f32_4x4x4_16b_bf16 v[140:143], v[144:145], v[98:99], v[140:143]
    ds_read_b64_tr_b16 v[112:113], v146 offset:9216
    ds_read_b64_tr_b16 v[114:115], v146 offset:9984
    ds_read_b64_tr_b16 v[116:117], v146 offset:9280
    ds_read_b64_tr_b16 v[118:119], v146 offset:10048
    ds_read_b64_tr_b16 v[120:121], v146 offset:9344
    ds_read_b64_tr_b16 v[122:123], v146 offset:10112
    s_waitcnt lgkmcnt(6)
    v_mfma_f32_4x4x4_16b_bf16 v[132:135], v[144:145], v[100:101], v[132:135]
    v_mfma_f32_4x4x4_16b_bf16 v[136:139], v[144:145], v[104:105], v[136:139]
    v_mfma_f32_4x4x4_16b_bf16 v[140:143], v[144:145], v[108:109], v[140:143]
    v_mfma_f32_4x4x4_16b_bf16 v[132:135], v[144:145], v[102:103], v[132:135]
    v_mfma_f32_4x4x4_16b_bf16 v[136:139], v[144:145], v[106:107], v[136:139]
    v_mfma_f32_4x4x4_16b_bf16 v[140:143], v[144:145], v[110:111], v[140:143]
    ds_read_b64_tr_b16 v[76:77], v146 offset:12288
    ds_read_b64_tr_b16 v[78:79], v146 offset:13056
    ds_read_b64_tr_b16 v[80:81], v146 offset:12352
    buffer_load_dwordx4 a[204:207], v1, s[32:35], s19 offen offset:0 sc1
    ds_read_b64_tr_b16 v[82:83], v146 offset:13120
    ds_read_b64_tr_b16 v[84:85], v146 offset:12416
    ds_read_b64_tr_b16 v[86:87], v146 offset:13184
    s_waitcnt lgkmcnt(6)
    v_mfma_f32_4x4x4_16b_bf16 v[132:135], v[144:145], v[112:113], v[132:135]
    v_mfma_f32_4x4x4_16b_bf16 v[136:139], v[144:145], v[116:117], v[136:139]
    v_mfma_f32_4x4x4_16b_bf16 v[140:143], v[144:145], v[120:121], v[140:143]
    v_mfma_f32_4x4x4_16b_bf16 v[132:135], v[144:145], v[114:115], v[132:135]
    v_mfma_f32_4x4x4_16b_bf16 v[136:139], v[144:145], v[118:119], v[136:139]
    v_mfma_f32_4x4x4_16b_bf16 v[140:143], v[144:145], v[122:123], v[140:143]
    ds_read_b64_tr_b16 v[88:89], v146 offset:15360
    ds_read_b64_tr_b16 v[90:91], v146 offset:16128
    ds_read_b64_tr_b16 v[92:93], v146 offset:15424
    ds_read_b64_tr_b16 v[94:95], v146 offset:16192
    ds_read_b64_tr_b16 v[96:97], v146 offset:15488
    ds_read_b64_tr_b16 v[98:99], v146 offset:16256
    s_waitcnt lgkmcnt(6)
    v_mfma_f32_4x4x4_16b_bf16 v[132:135], v[144:145], v[76:77], v[132:135]
    v_mfma_f32_4x4x4_16b_bf16 v[136:139], v[144:145], v[80:81], v[136:139]
    v_mfma_f32_4x4x4_16b_bf16 v[140:143], v[144:145], v[84:85], v[140:143]
    v_mfma_f32_4x4x4_16b_bf16 v[132:135], v[144:145], v[78:79], v[132:135]
    v_mfma_f32_4x4x4_16b_bf16 v[136:139], v[144:145], v[82:83], v[136:139]
    v_mfma_f32_4x4x4_16b_bf16 v[140:143], v[144:145], v[86:87], v[140:143]
    ds_read_b64_tr_b16 v[100:101], v146 offset:18432
    buffer_load_dwordx4 a[208:211], v1, s[32:35], s19 offen offset:1024 sc1
    ds_read_b64_tr_b16 v[102:103], v146 offset:19200
    ds_read_b64_tr_b16 v[104:105], v146 offset:18496
    ds_read_b64_tr_b16 v[106:107], v146 offset:19264
    ds_read_b64_tr_b16 v[108:109], v146 offset:18560
    ds_read_b64_tr_b16 v[110:111], v146 offset:19328
    s_waitcnt lgkmcnt(6)
    v_mfma_f32_4x4x4_16b_bf16 v[132:135], v[144:145], v[88:89], v[132:135]
    v_mfma_f32_4x4x4_16b_bf16 v[136:139], v[144:145], v[92:93], v[136:139]
    v_mfma_f32_4x4x4_16b_bf16 v[140:143], v[144:145], v[96:97], v[140:143]
    v_mfma_f32_4x4x4_16b_bf16 v[132:135], v[144:145], v[90:91], v[132:135]
    v_mfma_f32_4x4x4_16b_bf16 v[136:139], v[144:145], v[94:95], v[136:139]
    v_mfma_f32_4x4x4_16b_bf16 v[140:143], v[144:145], v[98:99], v[140:143]
    ds_read_b64_tr_b16 v[112:113], v146 offset:21504
    ds_read_b64_tr_b16 v[114:115], v146 offset:22272
    ds_read_b64_tr_b16 v[116:117], v146 offset:21568
    ds_read_b64_tr_b16 v[118:119], v146 offset:22336
    ds_read_b64_tr_b16 v[120:121], v146 offset:21632
    ds_read_b64_tr_b16 v[122:123], v146 offset:22400
    buffer_load_dwordx4 a[212:215], v1, s[32:35], s19 offen offset:2048 sc1
    s_waitcnt lgkmcnt(6)
    v_mfma_f32_4x4x4_16b_bf16 v[132:135], v[144:145], v[100:101], v[132:135]
    v_mfma_f32_4x4x4_16b_bf16 v[136:139], v[144:145], v[104:105], v[136:139]
    v_mfma_f32_4x4x4_16b_bf16 v[140:143], v[144:145], v[108:109], v[140:143]
    v_mfma_f32_4x4x4_16b_bf16 v[132:135], v[144:145], v[102:103], v[132:135]
    v_mfma_f32_4x4x4_16b_bf16 v[136:139], v[144:145], v[106:107], v[136:139]
    v_mfma_f32_4x4x4_16b_bf16 v[140:143], v[144:145], v[110:111], v[140:143]
    s_waitcnt lgkmcnt(0)
    v_mfma_f32_4x4x4_16b_bf16 v[132:135], v[144:145], v[112:113], v[132:135]
    v_mfma_f32_4x4x4_16b_bf16 v[136:139], v[144:145], v[116:117], v[136:139]
    v_mfma_f32_4x4x4_16b_bf16 v[140:143], v[144:145], v[120:121], v[140:143]
    v_mfma_f32_4x4x4_16b_bf16 v[132:135], v[144:145], v[114:115], v[132:135]
    v_mfma_f32_4x4x4_16b_bf16 v[136:139], v[144:145], v[118:119], v[136:139]
    v_mfma_f32_4x4x4_16b_bf16 v[140:143], v[144:145], v[122:123], v[140:143]
    buffer_load_dwordx4 a[216:219], v1, s[32:35], s19 offen offset:3072 sc1
    s_add_u32 s19, s19, 4096
    buffer_load_dwordx4 a[220:223], v1, s[32:35], s19 offen offset:0 sc1
    buffer_load_dwordx4 a[224:227], v1, s[32:35], s19 offen offset:1024 sc1
    buffer_load_dwordx4 a[228:231], v1, s[32:35], s19 offen offset:2048 sc1
    buffer_load_dwordx4 a[232:235], v1, s[32:35], s19 offen offset:3072 sc1
    s_add_u32 s19, s19, 4096
    buffer_load_dwordx4 a[236:239], v1, s[32:35], s19 offen offset:0 sc1
    buffer_load_dwordx4 a[240:243], v1, s[32:35], s19 offen offset:1024 sc1
    buffer_load_dwordx4 a[244:247], v1, s[32:35], s19 offen offset:2048 sc1
    buffer_load_dwordx4 a[248:251], v1, s[32:35], s19 offen offset:3072 sc1
    s_add_u32 s19, s19, 4096
    buffer_load_dwordx4 a[252:255], v1, s[32:35], s19 offen offset:0 sc1
    v_mov_b32 v3, v132
    v_mov_b32 v20, v136
    v_mov_b32 v21, v140
    s_lshl1_add_u32 s12, s6, s7
    s_lshl2_add_u32 s12, s12, s3
    s_add_u32 s12, s12, 64
    s_lshl_b32 s12, s12, 7
    s_mul_i32 s14, s6, 163840
    s_mul_i32 s15, s7, 81920
    s_add_u32 s14, s14, s15
    s_mul_i32 s15, s3, 5120
    s_add_u32 s14, s14, s15
    s_add_u32 s14, s14, 2097152
    s_add_u32 s15, s3, 1
    s_and_b32 s15, s15, 3
    s_mul_i32 s16, s15, 20480
    s_add_u32 s16, s16, s14
    s_mul_i32 s15, s15, 15360
    s_add_u32 s15, s15, 102400
    v_add_u32 v14, s15, v1
    s_add_u32 s15, s3, 2
    s_and_b32 s15, s15, 3
    s_mul_i32 s17, s15, 20480
    s_add_u32 s17, s17, s14
    s_mul_i32 s15, s15, 15360
    s_add_u32 s15, s15, 107520
    v_add_u32 v15, s15, v1
    s_add_u32 s15, s3, 3
    s_and_b32 s15, s15, 3
    s_mul_i32 s18, s15, 20480
    s_add_u32 s18, s18, s14
    s_mul_i32 s15, s15, 15360
    s_add_u32 s15, s15, 112640
    v_add_u32 v16, s15, v1
    s_add_u32 s15, s3, 4
    s_and_b32 s15, s15, 3
    s_mul_i32 s19, s15, 20480
    s_add_u32 s19, s19, s14
    s_mul_i32 s15, s15, 15360
    s_add_u32 s15, s15, 102400
    v_add_u32 v17, s15, v1
    v_add_u32 v18, 4096, v1
    v_add_u32 v19, 8192, v1
    s_lshr_b32 s15, s8, 1
    s_mul_i32 s20, s15, 20480
    s_and_b32 s15, s8, 1
    s_mul_i32 s15, s15, 2560
    s_add_u32 s20, s20, s15
    s_add_u32 s20, s20, s14
    s_waitcnt vmcnt(16)
    s_mov_b32 s65, 1
    s_atomic_add s65, s[32:33], s13
    s_add_u32 s69, s68, 0
    buffer_load_dwordx4 a[0:3], v1, s[32:35], s69 offen offset:0 sc1
    buffer_load_dwordx4 a[4:7], v1, s[32:35], s69 offen offset:1024 sc1
    buffer_load_dwordx4 a[8:11], v1, s[32:35], s69 offen offset:2048 sc1
    buffer_load_dwordx4 a[12:15], v1, s[32:35], s69 offen offset:3072 sc1
    s_add_u32 s69, s68, 4096
    buffer_load_dwordx4 a[16:19], v1, s[32:35], s69 offen offset:0 sc1
    buffer_load_dwordx4 a[20:23], v1, s[32:35], s69 offen offset:1024 sc1
    s_mov_b32 s66, 0
L_poll_12:
    s_mov_b32 s62, 0
    s_atomic_add s62, s[32:33], s12 glc
    s_add_u32 s66, s66, 1
    s_cmp_ge_u32 s66, 40000
    s_waitcnt lgkmcnt(0)
    s_cbranch_scc1 L_polled_13
    s_cmp_lt_u32 s62, 8
    s_cbranch_scc1 L_poll_12
L_polled_13:
    buffer_load_dwordx4 v[160:163], v1, s[32:35], s16 offen offset:0 sc1
    buffer_load_dwordx4 v[164:167], v1, s[32:35], s16 offen offset:1024 sc1
    buffer_load_dwordx4 v[168:171], v1, s[32:35], s16 offen offset:2048 sc1
    buffer_load_dwordx4 v[172:175], v1, s[32:35], s16 offen offset:3072 sc1
    buffer_load_dwordx4 v[176:179], v18, s[32:35], s16 offen offset:0 sc1
    buffer_load_dwordx4 v[180:183], v1, s[32:35], s17 offen offset:0 sc1
    s_waitcnt vmcnt(5)
    v_mfma_f32_16x16x32_bf16 v[52:55], a[156:159], v[160:163], 0
    buffer_load_dwordx4 v[184:187], v1, s[32:35], s17 offen offset:1024 sc1
    v_mfma_f32_16x16x32_bf16 v[56:59], a[160:163], v[160:163], 0
    v_mfma_f32_16x16x32_bf16 v[60:63], a[164:167], v[160:163], 0
    v_mfma_f32_16x16x32_bf16 v[64:67], a[168:171], v[160:163], 0
    buffer_load_dwordx4 v[188:191], v1, s[32:35], s17 offen offset:2048 sc1
    v_mfma_f32_16x16x32_bf16 v[68:71], a[172:175], v[160:163], 0
    s_waitcnt vmcnt(6)
    v_mfma_f32_16x16x32_bf16 v[52:55], a[176:179], v[164:167], v[52:55]
    v_mfma_f32_16x16x32_bf16 v[56:59], a[180:183], v[164:167], v[56:59]
    v_mfma_f32_16x16x32_bf16 v[60:63], a[184:187], v[164:167], v[60:63]
    v_mfma_f32_16x16x32_bf16 v[64:67], a[188:191], v[164:167], v[64:67]
    buffer_load_dwordx4 v[192:195], v1, s[32:35], s17 offen offset:3072 sc1
    v_mfma_f32_16x16x32_bf16 v[68:71], a[192:195], v[164:167], v[68:71]
    s_waitcnt vmcnt(6)
    v_mfma_f32_16x16x32_bf16 v[52:55], a[196:199], v[168:171], v[52:55]
    v_mfma_f32_16x16x32_bf16 v[56:59], a[200:203], v[168:171], v[56:59]
    v_mfma_f32_16x16x32_bf16 v[60:63], a[204:207], v[168:171], v[60:63]
    v_mfma_f32_16x16x32_bf16 v[64:67], a[208:211], v[168:171], v[64:67]
    buffer_load_dwordx4 v[196:199], v18, s[32:35], s17 offen offset:0 sc1
    v_mfma_f32_16x16x32_bf16 v[68:71], a[212:215], v[168:171], v[68:71]
    s_waitcnt vmcnt(6)
    v_mfma_f32_16x16x32_bf16 v[52:55], a[216:219], v[172:175], v[52:55]
    v_mfma_f32_16x16x32_bf16 v[56:59], a[220:223], v[172:175], v[56:59]
    v_mfma_f32_16x16x32_bf16 v[60:63], a[224:227], v[172:175], v[60:63]
    buffer_load_dwordx4 v[200:203], v1, s[32:35], s18 offen offset:0 sc1
    v_mfma_f32_16x16x32_bf16 v[64:67], a[228:231], v[172:175], v[64:67]
    v_mfma_f32_16x16x32_bf16 v[68:71], a[232:235], v[172:175], v[68:71]
    s_waitcnt vmcnt(6)
    v_mfma_f32_16x16x32_bf16 v[52:55], a[236:239], v[176:179], v[52:55]
    v_mfma_f32_16x16x32_bf16 v[56:59], a[240:243], v[176:179], v[56:59]
    v_mfma_f32_16x16x32_bf16 v[60:63], a[244:247], v[176:179], v[60:63]
    buffer_load_dwordx4 v[204:207], v1, s[32:35], s18 offen offset:1024 sc1
    v_mfma_f32_16x16x32_bf16 v[64:67], a[248:251], v[176:179], v[64:67]
    v_mfma_f32_16x16x32_bf16 v[68:71], a[252:255], v[176:179], v[68:71]
    s_waitcnt vmcnt(6)
    v_mfma_f32_16x16x32_bf16 v[72:75], a[156:159], v[180:183], 0
    v_mfma_f32_16x16x32_bf16 v[76:79], a[160:163], v[180:183], 0
    v_mfma_f32_16x16x32_bf16 v[80:83], a[164:167], v[180:183], 0
    buffer_load_dwordx4 v[208:211], v1, s[32:35], s18 offen offset:2048 sc1
    ds_write_b128 v14, v[52:55] offset:0
    v_mfma_f32_16x16x32_bf16 v[84:87], a[168:171], v[180:183], 0
    ds_write_b128 v14, v[56:59] offset:1024
    v_mfma_f32_16x16x32_bf16 v[88:91], a[172:175], v[180:183], 0
    ds_write_b128 v14, v[60:63] offset:2048
    s_waitcnt vmcnt(6)
    v_mfma_f32_16x16x32_bf16 v[72:75], a[176:179], v[184:187], v[72:75]
    ds_write_b128 v14, v[64:67] offset:3072
    v_mfma_f32_16x16x32_bf16 v[76:79], a[180:183], v[184:187], v[76:79]
    buffer_load_dwordx4 v[212:215], v1, s[32:35], s18 offen offset:3072 sc1
    ds_write_b128 v14, v[68:71] offset:4096
    v_mfma_f32_16x16x32_bf16 v[80:83], a[184:187], v[184:187], v[80:83]
    v_mfma_f32_16x16x32_bf16 v[84:87], a[188:191], v[184:187], v[84:87]
    v_mfma_f32_16x16x32_bf16 v[88:91], a[192:195], v[184:187], v[88:91]
    s_waitcnt vmcnt(6)
    v_mfma_f32_16x16x32_bf16 v[72:75], a[196:199], v[188:191], v[72:75]
    buffer_load_dwordx4 v[216:219], v18, s[32:35], s18 offen offset:0 sc1
    v_mfma_f32_16x16x32_bf16 v[76:79], a[200:203], v[188:191], v[76:79]
    v_mfma_f32_16x16x32_bf16 v[80:83], a[204:207], v[188:191], v[80:83]
    v_mfma_f32_16x16x32_bf16 v[84:87], a[208:211], v[188:191], v[84:87]
    v_mfma_f32_16x16x32_bf16 v[88:91], a[212:215], v[188:191], v[88:91]
    s_waitcnt vmcnt(6)
    v_mfma_f32_16x16x32_bf16 v[72:75], a[216:219], v[192:195], v[72:75]
    buffer_load_dwordx4 v[220:223], v1, s[32:35], s19 offen offset:0 sc1
    v_mfma_f32_16x16x32_bf16 v[76:79], a[220:223], v[192:195], v[76:79]
    v_mfma_f32_16x16x32_bf16 v[80:83], a[224:227], v[192:195], v[80:83]
    v_mfma_f32_16x16x32_bf16 v[84:87], a[228:231], v[192:195], v[84:87]
    v_mfma_f32_16x16x32_bf16 v[88:91], a[232:235], v[192:195], v[88:91]
    s_waitcnt vmcnt(6)
    v_mfma_f32_16x16x32_bf16 v[72:75], a[236:239], v[196:199], v[72:75]
    buffer_load_dwordx4 v[224:227], v1, s[32:35], s19 offen offset:1024 sc1
    v_mfma_f32_16x16x32_bf16 v[76:79], a[240:243], v[196:199], v[76:79]
    v_mfma_f32_16x16x32_bf16 v[80:83], a[244:247], v[196:199], v[80:83]
    v_mfma_f32_16x16x32_bf16 v[84:87], a[248:251], v[196:199], v[84:87]
    v_mfma_f32_16x16x32_bf16 v[88:91], a[252:255], v[196:199], v[88:91]
    s_waitcnt vmcnt(6)
    v_mfma_f32_16x16x32_bf16 v[92:95], a[156:159], v[200:203], 0
    buffer_load_dwordx4 v[228:231], v1, s[32:35], s19 offen offset:2048 sc1
    v_mfma_f32_16x16x32_bf16 v[96:99], a[160:163], v[200:203], 0
    v_mfma_f32_16x16x32_bf16 v[100:103], a[164:167], v[200:203], 0
    ds_write_b128 v15, v[72:75] offset:0
    v_mfma_f32_16x16x32_bf16 v[104:107], a[168:171], v[200:203], 0
    ds_write_b128 v15, v[76:79] offset:1024
    v_mfma_f32_16x16x32_bf16 v[108:111], a[172:175], v[200:203], 0
    buffer_load_dwordx4 v[232:235], v1, s[32:35], s19 offen offset:3072 sc1
    ds_write_b128 v15, v[80:83] offset:2048
    s_waitcnt vmcnt(7)
    v_mfma_f32_16x16x32_bf16 v[92:95], a[176:179], v[204:207], v[92:95]
    ds_write_b128 v15, v[84:87] offset:3072
    v_mfma_f32_16x16x32_bf16 v[96:99], a[180:183], v[204:207], v[96:99]
    ds_write_b128 v15, v[88:91] offset:4096
    v_mfma_f32_16x16x32_bf16 v[100:103], a[184:187], v[204:207], v[100:103]
    v_lshlrev_b32 v112, 16, v4
    v_and_b32 v113, 0xffff0000, v4
    buffer_load_dwordx4 v[236:239], v18, s[32:35], s19 offen offset:0 sc1
    v_mfma_f32_16x16x32_bf16 v[104:107], a[188:191], v[204:207], v[104:107]
    v_lshlrev_b32 v114, 16, v5
    v_and_b32 v115, 0xffff0000, v5
    v_mfma_f32_16x16x32_bf16 v[108:111], a[192:195], v[204:207], v[108:111]
    v_lshlrev_b32 v116, 16, v6
    v_and_b32 v117, 0xffff0000, v6
    s_waitcnt vmcnt(7)
    v_mfma_f32_16x16x32_bf16 v[92:95], a[196:199], v[208:211], v[92:95]
    v_lshlrev_b32 v118, 16, v7
    v_and_b32 v119, 0xffff0000, v7
    v_mfma_f32_16x16x32_bf16 v[96:99], a[200:203], v[208:211], v[96:99]
    buffer_load_dwordx4 a[24:27], v1, s[32:35], s69 offen offset:2048 sc1
    v_lshlrev_b32 v120, 16, v8
    v_and_b32 v121, 0xffff0000, v8
    v_mfma_f32_16x16x32_bf16 v[100:103], a[204:207], v[208:211], v[100:103]
    v_lshlrev_b32 v122, 16, v9
    v_and_b32 v123, 0xffff0000, v9
    v_mfma_f32_16x16x32_bf16 v[104:107], a[208:211], v[208:211], v[104:107]
    v_lshlrev_b32 v124, 16, v10
    v_and_b32 v125, 0xffff0000, v10
    v_mfma_f32_16x16x32_bf16 v[108:111], a[212:215], v[208:211], v[108:111]
    buffer_load_dwordx4 a[28:31], v1, s[32:35], s69 offen offset:3072 sc1
    v_lshlrev_b32 v126, 16, v11
    v_and_b32 v127, 0xffff0000, v11
    s_waitcnt vmcnt(8)
    v_mfma_f32_16x16x32_bf16 v[92:95], a[216:219], v[212:215], v[92:95]
    v_lshlrev_b32 v128, 16, v12
    v_and_b32 v129, 0xffff0000, v12
    v_mfma_f32_16x16x32_bf16 v[96:99], a[220:223], v[212:215], v[96:99]
    v_lshlrev_b32 v130, 16, v13
    v_and_b32 v131, 0xffff0000, v13
    v_mfma_f32_16x16x32_bf16 v[100:103], a[224:227], v[212:215], v[100:103]
    s_add_u32 s69, s68, 8192
    buffer_load_dwordx4 a[32:35], v1, s[32:35], s69 offen offset:0 sc1
    s_lshr_b32 s14, s3, 1
    s_lshl1_add_u32 s14, s7, s14
    v_mfma_f32_16x16x32_bf16 v[104:107], a[228:231], v[212:215], v[104:107]
    s_lshl2_add_u32 s13, s6, s14
    s_mul_i32 s14, s13, 40960
    v_mfma_f32_16x16x32_bf16 v[108:111], a[232:235], v[212:215], v[108:111]
    s_mul_i32 s15, s8, 5120
    s_add_u32 s14, s14, s15
    s_waitcnt vmcnt(8)
    v_mfma_f32_16x16x32_bf16 v[92:95], a[236:239], v[216:219], v[92:95]
    s_and_b32 s15, s3, 1
    s_lshl_b32 s15, s15, 8
    v_mfma_f32_16x16x32_bf16 v[96:99], a[240:243], v[216:219], v[96:99]
    buffer_load_dwordx4 a[36:39], v1, s[32:35], s69 offen offset:1024 sc1
    s_add_u32 s14, s14, s15
    s_add_u32 s14, s14, 5242880
    v_mfma_f32_16x16x32_bf16 v[100:103], a[244:247], v[216:219], v[100:103]
    s_add_u32 s13, s13, 192
    s_lshl_b32 s13, s13, 7
    v_mfma_f32_16x16x32_bf16 v[104:107], a[248:251], v[216:219], v[104:107]
    v_and_b32 v25, 15, v0
    v_lshrrev_b32 v26, 4, v0
    v_mfma_f32_16x16x32_bf16 v[108:111], a[252:255], v[216:219], v[108:111]
    v_lshlrev_b32 v27, 4, v25
    v_lshl_add_u32 v28, v26, 10, v27
    s_waitcnt vmcnt(8)
    v_mfma_f32_16x16x32_bf16 v[32:35], a[156:159], v[220:223], 0
    v_mfma_f32_16x16x32_bf16 v[36:39], a[160:163], v[220:223], 0
    v_mfma_f32_16x16x32_bf16 v[40:43], a[164:167], v[220:223], 0
    ds_write_b128 v16, v[92:95] offset:0
    v_mfma_f32_16x16x32_bf16 v[44:47], a[168:171], v[220:223], 0
    ds_write_b128 v16, v[96:99] offset:1024
    v_mfma_f32_16x16x32_bf16 v[48:51], a[172:175], v[220:223], 0
    ds_write_b128 v16, v[100:103] offset:2048
    s_waitcnt vmcnt(7)
    v_mfma_f32_16x16x32_bf16 v[32:35], a[176:179], v[224:227], v[32:35]
    ds_write_b128 v16, v[104:107] offset:3072
    v_mfma_f32_16x16x32_bf16 v[36:39], a[180:183], v[224:227], v[36:39]
    ds_write_b128 v16, v[108:111] offset:4096
    v_mfma_f32_16x16x32_bf16 v[40:43], a[184:187], v[224:227], v[40:43]
    v_lshrrev_b32 v29, 5, v0
    v_lshl_add_u32 v27, v29, 9, v27
    v_mfma_f32_16x16x32_bf16 v[44:47], a[188:191], v[224:227], v[44:47]
    v_and_b32 v26, 1, v26
    v_lshl_add_u32 v27, v26, 3, v27
    v_mfma_f32_16x16x32_bf16 v[48:51], a[192:195], v[224:227], v[48:51]
    v_add_u32 v27, 4096, v27
    v_lshlrev_b32 v25, 3, v25
    s_waitcnt lgkmcnt(0)
    s_barrier
    s_waitcnt vmcnt(6)
    v_mfma_f32_16x16x32_bf16 v[32:35], a[196:199], v[228:231], v[32:35]
    ds_read_b128 v[160:163], v17 offset:0
    v_mfma_f32_16x16x32_bf16 v[36:39], a[200:203], v[228:231], v[36:39]
    ds_read_b128 v[164:167], v17 offset:1024
    v_mfma_f32_16x16x32_bf16 v[40:43], a[204:207], v[228:231], v[40:43]
    ds_read_b128 v[168:171], v17 offset:2048
    v_mfma_f32_16x16x32_bf16 v[44:47], a[208:211], v[228:231], v[44:47]
    ds_read_b128 v[172:175], v17 offset:3072
    v_mfma_f32_16x16x32_bf16 v[48:51], a[212:215], v[228:231], v[48:51]
    ds_read_b128 v[176:179], v17 offset:4096
    s_waitcnt vmcnt(5)
    v_mfma_f32_16x16x32_bf16 v[32:35], a[216:219], v[232:235], v[32:35]
    ds_read_b128 v[180:183], v17 offset:5120
    v_mfma_f32_16x16x32_bf16 v[36:39], a[220:223], v[232:235], v[36:39]
    ds_read_b128 v[184:187], v17 offset:6144
    v_mfma_f32_16x16x32_bf16 v[40:43], a[224:227], v[232:235], v[40:43]
    ds_read_b128 v[188:191], v17 offset:7168
    v_mfma_f32_16x16x32_bf16 v[44:47], a[228:231], v[232:235], v[44:47]
    ds_read_b128 v[192:195], v17 offset:8192
    v_mfma_f32_16x16x32_bf16 v[48:51], a[232:235], v[232:235], v[48:51]
    ds_read_b128 v[196:199], v17 offset:9216
    s_waitcnt vmcnt(4)
    v_mfma_f32_16x16x32_bf16 v[32:35], a[236:239], v[236:239], v[32:35]
    ds_read_b128 v[200:203], v17 offset:10240
    v_mfma_f32_16x16x32_bf16 v[36:39], a[240:243], v[236:239], v[36:39]
    ds_read_b128 v[204:207], v17 offset:11264
    v_mfma_f32_16x16x32_bf16 v[40:43], a[244:247], v[236:239], v[40:43]
    ds_read_b128 v[208:211], v17 offset:12288
    v_mfma_f32_16x16x32_bf16 v[44:47], a[248:251], v[236:239], v[44:47]
    ds_read_b128 v[212:215], v17 offset:13312
    v_mfma_f32_16x16x32_bf16 v[48:51], a[252:255], v[236:239], v[48:51]
    ds_read_b128 v[216:219], v17 offset:14336
    s_lshl3_add_u32 s15, s6, s8
    s_lshl1_add_u32 s15, s15, s7
    s_lshl2_add_u32 s15, s15, s3
    s_lshl_b32 s15, s15, 7
    s_add_u32 s15, s15, 8126464
    s_waitcnt lgkmcnt(10)
    v_pk_add_f32 v[112:113], v[112:113], v[160:161]
    v_pk_add_f32 v[114:115], v[114:115], v[162:163]
    v_pk_add_f32 v[116:117], v[116:117], v[164:165]
    v_pk_add_f32 v[118:119], v[118:119], v[166:167]
    v_pk_add_f32 v[120:121], v[120:121], v[168:169]
    v_pk_add_f32 v[122:123], v[122:123], v[170:171]
    v_pk_add_f32 v[124:125], v[124:125], v[172:173]
    v_pk_add_f32 v[126:127], v[126:127], v[174:175]
    v_pk_add_f32 v[128:129], v[128:129], v[176:177]
    v_pk_add_f32 v[130:131], v[130:131], v[178:179]
    s_waitcnt lgkmcnt(5)
    v_pk_add_f32 v[112:113], v[112:113], v[180:181]
    v_pk_add_f32 v[114:115], v[114:115], v[182:183]
    v_pk_add_f32 v[116:117], v[116:117], v[184:185]
    v_pk_add_f32 v[118:119], v[118:119], v[186:187]
    v_pk_add_f32 v[120:121], v[120:121], v[188:189]
    v_pk_add_f32 v[122:123], v[122:123], v[190:191]
    v_pk_add_f32 v[124:125], v[124:125], v[192:193]
    v_pk_add_f32 v[126:127], v[126:127], v[194:195]
    v_pk_add_f32 v[128:129], v[128:129], v[196:197]
    v_pk_add_f32 v[130:131], v[130:131], v[198:199]
    s_waitcnt lgkmcnt(0)
    v_pk_add_f32 v[112:113], v[112:113], v[200:201]
    v_pk_add_f32 v[114:115], v[114:115], v[202:203]
    v_pk_add_f32 v[116:117], v[116:117], v[204:205]
    v_pk_add_f32 v[118:119], v[118:119], v[206:207]
    v_pk_add_f32 v[120:121], v[120:121], v[208:209]
    v_pk_add_f32 v[122:123], v[122:123], v[210:211]
    v_pk_add_f32 v[124:125], v[124:125], v[212:213]
    v_pk_add_f32 v[126:127], v[126:127], v[214:215]
    v_pk_add_f32 v[128:129], v[128:129], v[216:217]
    v_pk_add_f32 v[130:131], v[130:131], v[218:219]
    v_pk_add_f32 v[112:113], v[112:113], v[32:33]
    v_pk_add_f32 v[114:115], v[114:115], v[34:35]
    v_pk_add_f32 v[116:117], v[116:117], v[36:37]
    v_pk_add_f32 v[118:119], v[118:119], v[38:39]
    v_pk_add_f32 v[120:121], v[120:121], v[40:41]
    v_pk_add_f32 v[122:123], v[122:123], v[42:43]
    v_pk_add_f32 v[124:125], v[124:125], v[44:45]
    v_pk_add_f32 v[126:127], v[126:127], v[46:47]
    v_pk_add_f32 v[128:129], v[128:129], v[48:49]
    v_pk_add_f32 v[130:131], v[130:131], v[50:51]
    v_cvt_pk_bf16_f32 v4, v112, v113
    v_cvt_pk_bf16_f32 v5, v114, v115
    v_cvt_pk_bf16_f32 v6, v116, v117
    v_cvt_pk_bf16_f32 v7, v118, v119
    v_cvt_pk_bf16_f32 v8, v120, v121
    v_cvt_pk_bf16_f32 v9, v122, v123
    v_cvt_pk_bf16_f32 v10, v124, v125
    v_cvt_pk_bf16_f32 v11, v126, v127
    v_cvt_pk_bf16_f32 v12, v128, v129
    v_cvt_pk_bf16_f32 v13, v130, v131
    buffer_store_dwordx4 v[4:7], v28, s[32:35], s14 offen sc1
    buffer_store_dwordx4 v[8:11], v28, s[32:35], s14 offen offset:512 sc1
    buffer_store_dwordx2 v[12:13], v27, s[32:35], s14 offen sc1
    v_pk_add_f32 v[32:33], v[112:113], v[114:115]
    v_pk_mul_f32 v[34:35], v[112:113], v[112:113]
    v_pk_fma_f32 v[34:35], v[114:115], v[114:115], v[34:35]
    v_pk_add_f32 v[32:33], v[32:33], v[116:117]
    v_pk_fma_f32 v[34:35], v[116:117], v[116:117], v[34:35]
    v_pk_add_f32 v[32:33], v[32:33], v[118:119]
    v_pk_fma_f32 v[34:35], v[118:119], v[118:119], v[34:35]
    v_pk_add_f32 v[32:33], v[32:33], v[120:121]
    v_pk_fma_f32 v[34:35], v[120:121], v[120:121], v[34:35]
    v_pk_add_f32 v[32:33], v[32:33], v[122:123]
    v_pk_fma_f32 v[34:35], v[122:123], v[122:123], v[34:35]
    v_pk_add_f32 v[32:33], v[32:33], v[124:125]
    v_pk_fma_f32 v[34:35], v[124:125], v[124:125], v[34:35]
    v_pk_add_f32 v[32:33], v[32:33], v[126:127]
    v_pk_fma_f32 v[34:35], v[126:127], v[126:127], v[34:35]
    v_pk_add_f32 v[32:33], v[32:33], v[128:129]
    v_pk_fma_f32 v[34:35], v[128:129], v[128:129], v[34:35]
    v_pk_add_f32 v[32:33], v[32:33], v[130:131]
    v_pk_fma_f32 v[34:35], v[130:131], v[130:131], v[34:35]
    v_add_f32 v32, v32, v33
    v_add_f32 v33, v34, v35
    v_mov_b32 v34, v32
    v_mov_b32 v35, v33
    s_nop 0
    v_permlane16_swap_b32 v32, v34
    v_permlane16_swap_b32 v33, v35
    v_pk_add_f32 v[32:33], v[32:33], v[34:35]
    v_mov_b32 v34, v32
    v_mov_b32 v35, v33
    s_nop 0
    v_permlane32_swap_b32 v32, v34
    v_permlane32_swap_b32 v33, v35
    v_pk_add_f32 v[32:33], v[32:33], v[34:35]
    s_mov_b64 exec, 0xffff
    buffer_store_dwordx2 v[32:33], v25, s[32:35], s15 offen sc1
    s_mov_b64 exec, -1
    s_barrier
    s_mul_i32 s18, s3, 3072
    s_mov_b32 s67, 1572864
    s_add_u32 m0, s18, 98304
    s_nop 0
    buffer_load_dwordx4 v22, s[36:39], s67 offen lds
    s_mov_b32 s67, 1572864
    s_add_u32 m0, s18, 99328
    s_nop 0
    buffer_load_dwordx4 v23, s[36:39], s67 offen lds
    s_mov_b32 s67, 1572864
    s_add_u32 m0, s18, 100352
    s_nop 0
    buffer_load_dwordx4 v24, s[36:39], s67 offen lds
    s_mov_b32 s67, 1769472
    s_add_u32 m0, s18, 110592
    s_nop 0
    buffer_load_dwordx4 v22, s[36:39], s67 offen lds
    s_mov_b32 s67, 1769472
    s_add_u32 m0, s18, 111616
    s_nop 0
    buffer_load_dwordx4 v23, s[36:39], s67 offen lds
    s_mov_b32 s67, 1769472
    s_add_u32 m0, s18, 112640
    s_nop 0
    buffer_load_dwordx4 v24, s[36:39], s67 offen lds
    v_accvgpr_write_b32 a240, v4
    v_accvgpr_write_b32 a241, v5
    v_accvgpr_write_b32 a242, v6
    v_accvgpr_write_b32 a243, v7
    v_accvgpr_write_b32 a244, v8
    v_accvgpr_write_b32 a245, v9
    v_accvgpr_write_b32 a246, v10
    v_accvgpr_write_b32 a247, v11
    v_accvgpr_write_b32 a248, v12
    v_accvgpr_write_b32 a249, v13
    v_accvgpr_write_b32 a250, v2
    buffer_load_dwordx4 a[40:43], v1, s[32:35], s69 offen offset:2048 sc1
    buffer_load_dwordx4 a[44:47], v1, s[32:35], s69 offen offset:3072 sc1
    s_add_u32 s69, s68, 12288
    buffer_load_dwordx4 a[48:51], v1, s[32:35], s69 offen offset:0 sc1
    buffer_load_dwordx4 a[52:55], v1, s[32:35], s69 offen offset:1024 sc1
    v_lshrrev_b32 v25, 5, v0
    v_bfe_u32 v26, v0, 2, 2
    v_bfe_u32 v27, v0, 4, 1
    v_and_b32 v28, 3, v0
    v_lshl_add_u32 v27, v27, 2, v28
    v_mul_u32_u24 v26, 192, v26
    v_lshl_add_u32 v26, v27, 3, v26
    v_mul_u32_u24 v27, 1536, v25
    v_add_u32 v14, v26, v27
    v_add_u32 v15, 61440, v14
    v_mul_u32_u24 v27, 7680, v25
    v_add_u32 v16, v26, v27
    v_add_u32 v17, 61440, v16
    s_mul_i32 s16, s3, 6144
    s_add_u32 s16, s16, 98304
    v_add_u32 v18, s16, v14
    v_lshlrev_b32 v22, 4, v25
    v_add_u32 v22, 124928, v22
    v_and_b32 v26, 31, v0
    v_lshlrev_b32 v26, 3, v26
    v_lshl_add_u32 v19, v25, 12, v26
    v_bfe_u32 v23, v0, 4, 1
    v_mul_u32_u24 v23, 49152, v23
    v_and_b32 v26, 15, v0
    v_lshl_add_u32 v23, v26, 4, v23
    v_lshl_add_u32 v23, v25, 8, v23
    s_lshl2_add_u32 s19, s1, s3
    s_mul_i32 s14, s19, 40960
    s_add_u32 s14, s14, 5242880
    s_mul_i32 s20, s9, 2560
    s_add_u32 s20, s20, s14
    s_add_u32 s19, s19, 192
    s_lshl_b32 s19, s19, 7
    s_lshl_b32 s15, s1, 13
    s_lshl_b32 s16, s3, 8
    s_add_u32 s15, s15, s16
    s_add_u32 s15, s15, 8126464
    ds_read_b64_tr_b16 v[72:73], v14 offset:0
    ds_read_b64_tr_b16 v[74:75], v14 offset:768
    ds_read_b64_tr_b16 v[76:77], v14 offset:64
    ds_read_b64_tr_b16 v[78:79], v14 offset:832
    ds_read_b64_tr_b16 v[80:81], v14 offset:128
    ds_read_b64_tr_b16 v[82:83], v14 offset:896
    s_waitcnt lgkmcnt(0)
    s_waitcnt vmcnt(10)
    s_mov_b32 s65, 1
    s_atomic_add s65, s[32:33], s13
    buffer_load_dwordx4 a[56:59], v1, s[32:35], s69 offen offset:2048 sc1
    buffer_load_dwordx4 a[60:63], v1, s[32:35], s69 offen offset:3072 sc1
    s_add_u32 s69, s68, 16384
    buffer_load_dwordx4 a[64:67], v1, s[32:35], s69 offen offset:0 sc1
    buffer_load_dwordx4 a[68:71], v1, s[32:35], s69 offen offset:1024 sc1
    buffer_load_dwordx4 a[72:75], v1, s[32:35], s69 offen offset:2048 sc1
    buffer_load_dwordx4 a[76:79], v1, s[32:35], s69 offen offset:3072 sc1
    s_add_u32 s69, s68, 20480
    buffer_load_dwordx4 a[80:83], v1, s[32:35], s69 offen offset:0 sc1
    buffer_load_dwordx4 a[84:87], v1, s[32:35], s69 offen offset:1024 sc1
    buffer_load_dwordx4 a[88:91], v1, s[32:35], s69 offen offset:2048 sc1
    buffer_load_dwordx4 a[92:95], v1, s[32:35], s69 offen offset:3072 sc1
    s_mov_b32 s66, 0
L_poll_15:
    s_mov_b32 s62, 0
    s_atomic_add s62, s[32:33], s19 glc
    s_add_u32 s66, s66, 1
    s_cmp_ge_u32 s66, 40000
    s_waitcnt lgkmcnt(0)
    s_cbranch_scc1 L_polled_16
    s_cmp_lt_u32 s62, 16
    s_cbranch_scc1 L_poll_15
L_polled_16:
    s_waitcnt vmcnt(10)
    buffer_load_dwordx4 v[96:99], v1, s[32:35], s14 offen offset:0 sc1
    buffer_load_dwordx4 v[100:103], v1, s[32:35], s14 offen offset:1024 sc1
    buffer_load_dwordx4 v[104:107], v1, s[32:35], s14 offen offset:2048 sc1
    buffer_load_dwordx4 v[108:111], v1, s[32:35], s14 offen offset:3072 sc1
    s_add_u32 s14, s14, 4096
    buffer_load_dwordx4 v[112:115], v1, s[32:35], s14 offen offset:0 sc1
    buffer_load_dwordx4 v[116:119], v1, s[32:35], s14 offen offset:1024 sc1
    s_waitcnt vmcnt(5)
    v_mfma_f32_32x32x16_bf16 v[24:39], v[72:75], v[96:99], 0
    buffer_load_dwordx4 v[120:123], v1, s[32:35], s14 offen offset:2048 sc1
    ds_read_b64_tr_b16 v[84:85], v14 offset:3840
    buffer_load_dwordx4 v[124:127], v1, s[32:35], s14 offen offset:3072 sc1
    s_add_u32 s14, s14, 4096
    ds_read_b64_tr_b16 v[86:87], v14 offset:4608
    ds_read_b64_tr_b16 v[88:89], v14 offset:3904
    v_mfma_f32_32x32x16_bf16 v[40:55], v[76:79], v[96:99], 0
    ds_read_b64_tr_b16 v[90:91], v14 offset:4672
    ds_read_b64_tr_b16 v[92:93], v14 offset:3968
    ds_read_b64_tr_b16 v[94:95], v14 offset:4736
    v_mfma_f32_32x32x16_bf16 v[56:71], v[80:83], v[96:99], 0
    buffer_load_dwordx4 v[128:131], v1, s[32:35], s14 offen offset:0 sc1
    s_waitcnt lgkmcnt(0)
    s_waitcnt vmcnt(7)
    v_mfma_f32_32x32x16_bf16 v[24:39], v[84:87], v[100:103], v[24:39]
    ds_read_b64_tr_b16 v[72:73], v14 offset:7680
    ds_read_b64_tr_b16 v[74:75], v14 offset:8448
    ds_read_b64_tr_b16 v[76:77], v14 offset:7744
    v_mfma_f32_32x32x16_bf16 v[40:55], v[88:91], v[100:103], v[40:55]
    buffer_load_dwordx4 v[132:135], v1, s[32:35], s14 offen offset:1024 sc1
    ds_read_b64_tr_b16 v[78:79], v14 offset:8512
    ds_read_b64_tr_b16 v[80:81], v14 offset:7808
    ds_read_b64_tr_b16 v[82:83], v14 offset:8576
    v_mfma_f32_32x32x16_bf16 v[56:71], v[92:95], v[100:103], v[56:71]
    buffer_load_dwordx4 v[136:139], v1, s[32:35], s14 offen offset:2048 sc1
    s_waitcnt lgkmcnt(0)
    s_waitcnt vmcnt(8)
    v_mfma_f32_32x32x16_bf16 v[24:39], v[72:75], v[104:107], v[24:39]
    ds_read_b64_tr_b16 v[84:85], v14 offset:11520
    ds_read_b64_tr_b16 v[86:87], v14 offset:12288
    ds_read_b64_tr_b16 v[88:89], v14 offset:11584
    v_mfma_f32_32x32x16_bf16 v[40:55], v[76:79], v[104:107], v[40:55]
    buffer_load_dwordx4 v[140:143], v1, s[32:35], s14 offen offset:3072 sc1
    s_add_u32 s14, s14, 4096
    ds_read_b64_tr_b16 v[90:91], v14 offset:12352
    ds_read_b64_tr_b16 v[92:93], v14 offset:11648
    ds_read_b64_tr_b16 v[94:95], v14 offset:12416
    v_mfma_f32_32x32x16_bf16 v[56:71], v[80:83], v[104:107], v[56:71]
    s_waitcnt lgkmcnt(0)
    s_waitcnt vmcnt(8)
    v_mfma_f32_32x32x16_bf16 v[24:39], v[84:87], v[108:111], v[24:39]
    buffer_load_dwordx4 v[144:147], v1, s[32:35], s14 offen offset:0 sc1
    ds_read_b64_tr_b16 v[72:73], v16 offset:3072
    ds_read_b64_tr_b16 v[74:75], v16 offset:6912
    ds_read_b64_tr_b16 v[76:77], v16 offset:3136
    v_mfma_f32_32x32x16_bf16 v[40:55], v[88:91], v[108:111], v[40:55]
    ds_read_b64_tr_b16 v[78:79], v16 offset:6976
    buffer_load_dwordx4 v[148:151], v1, s[32:35], s14 offen offset:1024 sc1
    ds_read_b64_tr_b16 v[80:81], v16 offset:3200
    ds_read_b64_tr_b16 v[82:83], v16 offset:7040
    v_mfma_f32_32x32x16_bf16 v[56:71], v[92:95], v[108:111], v[56:71]
    s_waitcnt lgkmcnt(0)
    s_waitcnt vmcnt(9)
    v_mfma_f32_32x32x16_bf16 v[24:39], v[72:75], v[112:115], v[24:39]
    buffer_load_dwordx4 v[152:155], v1, s[32:35], s14 offen offset:2048 sc1
    ds_read_b64_tr_b16 v[84:85], v14 offset:15360
    ds_read_b64_tr_b16 v[86:87], v14 offset:16128
    ds_read_b64_tr_b16 v[88:89], v14 offset:15424
    v_mfma_f32_32x32x16_bf16 v[40:55], v[76:79], v[112:115], v[40:55]
    ds_read_b64_tr_b16 v[90:91], v14 offset:16192
    ds_read_b64_tr_b16 v[92:93], v14 offset:15488
    ds_read_b64_tr_b16 v[94:95], v14 offset:16256
    v_mfma_f32_32x32x16_bf16 v[56:71], v[80:83], v[112:115], v[56:71]
    buffer_load_dwordx4 v[156:159], v1, s[32:35], s14 offen offset:3072 sc1
    s_add_u32 s14, s14, 4096
    s_waitcnt lgkmcnt(0)
    s_waitcnt vmcnt(10)
    v_mfma_f32_32x32x16_bf16 v[24:39], v[84:87], v[116:119], v[24:39]
    ds_read_b64_tr_b16 v[72:73], v14 offset:19200
    ds_read_b64_tr_b16 v[74:75], v14 offset:19968
    buffer_load_dwordx4 v[160:163], v1, s[32:35], s14 offen offset:0 sc1
    ds_read_b64_tr_b16 v[76:77], v14 offset:19264
    v_mfma_f32_32x32x16_bf16 v[40:55], v[88:91], v[116:119], v[40:55]
    ds_read_b64_tr_b16 v[78:79], v14 offset:20032
    ds_read_b64_tr_b16 v[80:81], v14 offset:19328
    ds_read_b64_tr_b16 v[82:83], v14 offset:20096
    v_mfma_f32_32x32x16_bf16 v[56:71], v[92:95], v[116:119], v[56:71]
    buffer_load_dwordx4 v[164:167], v1, s[32:35], s14 offen offset:1024 sc1
    s_waitcnt lgkmcnt(0)
    s_waitcnt vmcnt(11)
    v_mfma_f32_32x32x16_bf16 v[24:39], v[72:75], v[120:123], v[24:39]
    ds_read_b64_tr_b16 v[84:85], v14 offset:23040
    ds_read_b64_tr_b16 v[86:87], v14 offset:23808
    ds_read_b64_tr_b16 v[88:89], v14 offset:23104
    v_mfma_f32_32x32x16_bf16 v[40:55], v[76:79], v[120:123], v[40:55]
    buffer_load_dwordx4 v[168:171], v1, s[32:35], s14 offen offset:2048 sc1
    ds_read_b64_tr_b16 v[90:91], v14 offset:23872
    ds_read_b64_tr_b16 v[92:93], v14 offset:23168
    ds_read_b64_tr_b16 v[94:95], v14 offset:23936
    v_mfma_f32_32x32x16_bf16 v[56:71], v[80:83], v[120:123], v[56:71]
    s_waitcnt lgkmcnt(0)
    s_waitcnt vmcnt(11)
    v_mfma_f32_32x32x16_bf16 v[24:39], v[84:87], v[124:127], v[24:39]
    buffer_load_dwordx4 v[172:175], v1, s[32:35], s14 offen offset:3072 sc1
    s_add_u32 s14, s14, 4096
    ds_read_b64_tr_b16 v[72:73], v14 offset:26880
    ds_read_b64_tr_b16 v[74:75], v14 offset:27648
    ds_read_b64_tr_b16 v[76:77], v14 offset:26944
    v_mfma_f32_32x32x16_bf16 v[40:55], v[88:91], v[124:127], v[40:55]
    buffer_load_dwordx4 v[176:179], v1, s[32:35], s14 offen offset:0 sc1
    ds_read_b64_tr_b16 v[78:79], v14 offset:27712
    ds_read_b64_tr_b16 v[80:81], v14 offset:27008
    ds_read_b64_tr_b16 v[82:83], v14 offset:27776
    v_mfma_f32_32x32x16_bf16 v[56:71], v[92:95], v[124:127], v[56:71]
    s_waitcnt lgkmcnt(0)
    s_waitcnt vmcnt(12)
    v_mfma_f32_32x32x16_bf16 v[24:39], v[72:75], v[128:131], v[24:39]
    buffer_load_dwordx4 v[180:183], v1, s[32:35], s14 offen offset:1024 sc1
    ds_read_b64_tr_b16 v[84:85], v16 offset:18432
    ds_read_b64_tr_b16 v[86:87], v16 offset:22272
    ds_read_b64_tr_b16 v[88:89], v16 offset:18496
    v_mfma_f32_32x32x16_bf16 v[40:55], v[76:79], v[128:131], v[40:55]
    ds_read_b64_tr_b16 v[90:91], v16 offset:22336
    ds_read_b64_tr_b16 v[92:93], v16 offset:18560
    ds_read_b64_tr_b16 v[94:95], v16 offset:22400
    buffer_load_dwordx4 v[184:187], v1, s[32:35], s14 offen offset:2048 sc1
    v_mfma_f32_32x32x16_bf16 v[56:71], v[80:83], v[128:131], v[56:71]
    s_waitcnt lgkmcnt(0)
    s_waitcnt vmcnt(13)
    v_mfma_f32_32x32x16_bf16 v[24:39], v[84:87], v[132:135], v[24:39]
    buffer_load_dwordx4 v[188:191], v1, s[32:35], s14 offen offset:3072 sc1
    s_add_u32 s14, s14, 4096
    ds_read_b64_tr_b16 v[72:73], v14 offset:30720
    ds_read_b64_tr_b16 v[74:75], v14 offset:31488
    ds_read_b64_tr_b16 v[76:77], v14 offset:30784
    v_mfma_f32_32x32x16_bf16 v[40:55], v[88:91], v[132:135], v[40:55]
    ds_read_b64_tr_b16 v[78:79], v14 offset:31552
    ds_read_b64_tr_b16 v[80:81], v14 offset:30848
    ds_read_b64_tr_b16 v[82:83], v14 offset:31616
    v_mfma_f32_32x32x16_bf16 v[56:71], v[92:95], v[132:135], v[56:71]
    buffer_load_dwordx4 v[192:195], v1, s[32:35], s14 offen offset:0 sc1
    s_waitcnt lgkmcnt(0)
    s_waitcnt vmcnt(14)
    v_mfma_f32_32x32x16_bf16 v[24:39], v[72:75], v[136:139], v[24:39]
    ds_read_b64_tr_b16 v[84:85], v14 offset:34560
    ds_read_b64_tr_b16 v[86:87], v14 offset:35328
    ds_read_b64_tr_b16 v[88:89], v14 offset:34624
    v_mfma_f32_32x32x16_bf16 v[40:55], v[76:79], v[136:139], v[40:55]
    buffer_load_dwordx4 v[196:199], v1, s[32:35], s14 offen offset:1024 sc1
    ds_read_b64_tr_b16 v[90:91], v14 offset:35392
    ds_read_b64_tr_b16 v[92:93], v14 offset:34688
    ds_read_b64_tr_b16 v[94:95], v14 offset:35456
    v_mfma_f32_32x32x16_bf16 v[56:71], v[80:83], v[136:139], v[56:71]
    buffer_load_dwordx4 v[200:203], v1, s[32:35], s14 offen offset:2048 sc1
    s_waitcnt lgkmcnt(0)
    s_waitcnt vmcnt(15)
    v_mfma_f32_32x32x16_bf16 v[24:39], v[84:87], v[140:143], v[24:39]
    ds_read_b64_tr_b16 v[72:73], v14 offset:38400
    ds_read_b64_tr_b16 v[74:75], v14 offset:39168
    ds_read_b64_tr_b16 v[76:77], v14 offset:38464
    v_mfma_f32_32x32x16_bf16 v[40:55], v[88:91], v[140:143], v[40:55]
    buffer_load_dwordx4 v[204:207], v1, s[32:35], s14 offen offset:3072 sc1
    s_add_u32 s14, s14, 4096
    ds_read_b64_tr_b16 v[78:79], v14 offset:39232
    ds_read_b64_tr_b16 v[80:81], v14 offset:38528
    ds_read_b64_tr_b16 v[82:83], v14 offset:39296
    v_mfma_f32_32x32x16_bf16 v[56:71], v[92:95], v[140:143], v[56:71]
    s_waitcnt lgkmcnt(0)
    s_waitcnt vmcnt(15)
    v_mfma_f32_32x32x16_bf16 v[24:39], v[72:75], v[144:147], v[24:39]
    buffer_load_dwordx4 v[208:211], v1, s[32:35], s14 offen offset:0 sc1
    ds_read_b64_tr_b16 v[84:85], v14 offset:42240
    ds_read_b64_tr_b16 v[86:87], v14 offset:43008
    ds_read_b64_tr_b16 v[88:89], v14 offset:42304
    v_mfma_f32_32x32x16_bf16 v[40:55], v[76:79], v[144:147], v[40:55]
    ds_read_b64_tr_b16 v[90:91], v14 offset:43072
    buffer_load_dwordx4 v[212:215], v1, s[32:35], s14 offen offset:1024 sc1
    ds_read_b64_tr_b16 v[92:93], v14 offset:42368
    ds_read_b64_tr_b16 v[94:95], v14 offset:43136
    v_mfma_f32_32x32x16_bf16 v[56:71], v[80:83], v[144:147], v[56:71]
    s_waitcnt lgkmcnt(0)
    s_waitcnt vmcnt(16)
    v_mfma_f32_32x32x16_bf16 v[24:39], v[84:87], v[148:151], v[24:39]
    buffer_load_dwordx4 v[216:219], v1, s[32:35], s14 offen offset:2048 sc1
    ds_read_b64_tr_b16 v[72:73], v16 offset:33792
    ds_read_b64_tr_b16 v[74:75], v16 offset:37632
    ds_read_b64_tr_b16 v[76:77], v16 offset:33856
    v_mfma_f32_32x32x16_bf16 v[40:55], v[88:91], v[148:151], v[40:55]
    ds_read_b64_tr_b16 v[78:79], v16 offset:37696
    ds_read_b64_tr_b16 v[80:81], v16 offset:33920
    ds_read_b64_tr_b16 v[82:83], v16 offset:37760
    v_mfma_f32_32x32x16_bf16 v[56:71], v[92:95], v[148:151], v[56:71]
    buffer_load_dwordx4 v[220:223], v1, s[32:35], s14 offen offset:3072 sc1
    s_add_u32 s14, s14, 4096
    s_barrier
    s_waitcnt lgkmcnt(0)
    s_waitcnt vmcnt(17)
    v_mfma_f32_32x32x16_bf16 v[24:39], v[72:75], v[152:155], v[24:39]
    ds_read_b64_tr_b16 v[84:85], v14 offset:46080
    buffer_load_dwordx4 v[224:227], v1, s[32:35], s14 offen offset:0 sc1
    ds_read_b64_tr_b16 v[86:87], v14 offset:46848
    ds_read_b64_tr_b16 v[88:89], v14 offset:46144
    v_mfma_f32_32x32x16_bf16 v[40:55], v[76:79], v[152:155], v[40:55]
    ds_read_b64_tr_b16 v[90:91], v14 offset:46912
    ds_read_b64_tr_b16 v[92:93], v14 offset:46208
    ds_read_b64_tr_b16 v[94:95], v14 offset:46976
    v_mfma_f32_32x32x16_bf16 v[56:71], v[80:83], v[152:155], v[56:71]
    buffer_load_dwordx4 v[228:231], v1, s[32:35], s14 offen offset:1024 sc1
    ds_read_b64_tr_b16 v[96:97], v18 offset:0
    ds_read_b64_tr_b16 v[98:99], v18 offset:768
    ds_read_b64_tr_b16 v[100:101], v18 offset:64
    ds_read_b64_tr_b16 v[102:103], v18 offset:832
    ds_read_b64_tr_b16 v[104:105], v18 offset:128
    ds_read_b64_tr_b16 v[106:107], v18 offset:896
    s_waitcnt lgkmcnt(6)
    s_waitcnt vmcnt(18)
    v_mfma_f32_32x32x16_bf16 v[24:39], v[84:87], v[156:159], v[24:39]
    buffer_load_dwordx4 v[232:235], v1, s[32:35], s14 offen offset:2048 sc1
    ds_read_b64_tr_b16 v[72:73], v14 offset:49920
    ds_read_b64_tr_b16 v[74:75], v14 offset:50688
    ds_read_b64_tr_b16 v[76:77], v14 offset:49984
    v_mfma_f32_32x32x16_bf16 v[40:55], v[88:91], v[156:159], v[40:55]
    ds_read_b64_tr_b16 v[78:79], v14 offset:50752
    ds_read_b64_tr_b16 v[80:81], v14 offset:50048
    ds_read_b64_tr_b16 v[82:83], v14 offset:50816
    v_mfma_f32_32x32x16_bf16 v[56:71], v[92:95], v[156:159], v[56:71]
    buffer_load_dwordx4 v[236:239], v1, s[32:35], s14 offen offset:3072 sc1
    s_add_u32 s14, s14, 4096
    ds_read_b64_tr_b16 v[108:109], v18 offset:3072
    ds_read_b64_tr_b16 v[110:111], v18 offset:3840
    ds_read_b64_tr_b16 v[112:113], v18 offset:3136
    ds_read_b64_tr_b16 v[114:115], v18 offset:3904
    ds_read_b64_tr_b16 v[116:117], v18 offset:3200
    ds_read_b64_tr_b16 v[118:119], v18 offset:3968
    s_waitcnt lgkmcnt(6)
    s_waitcnt vmcnt(19)
    v_mfma_f32_32x32x16_bf16 v[24:39], v[72:75], v[160:163], v[24:39]
    buffer_load_dwordx4 v[240:243], v1, s[32:35], s14 offen offset:0 sc1
    ds_read_b64_tr_b16 v[84:85], v14 offset:53760
    ds_read_b64_tr_b16 v[86:87], v14 offset:54528
    ds_read_b64_tr_b16 v[88:89], v14 offset:53824
    v_mfma_f32_32x32x16_bf16 v[40:55], v[76:79], v[160:163], v[40:55]
    ds_read_b64_tr_b16 v[90:91], v14 offset:54592
    ds_read_b64_tr_b16 v[92:93], v14 offset:53888
    ds_read_b64_tr_b16 v[94:95], v14 offset:54656
    v_mfma_f32_32x32x16_bf16 v[56:71], v[80:83], v[160:163], v[56:71]
    buffer_load_dwordx4 v[244:247], v1, s[32:35], s14 offen offset:1024 sc1
    v_mov_b32 v132, 0x3f803f80
    v_mov_b32 v133, 0x3f803f80
    v_and_b32 v134, 31, v0
    v_lshlrev_b32 v135, 4, v134
    v_add_u32 v135, 122880, v135
    v_lshlrev_b32 v134, 2, v134
    s_waitcnt lgkmcnt(0)
    s_waitcnt vmcnt(20)
    v_mfma_f32_32x32x16_bf16 v[24:39], v[84:87], v[164:167], v[24:39]
    buffer_load_dwordx4 v[248:251], v1, s[32:35], s14 offen offset:2048 sc1
    ds_read_b64_tr_b16 v[72:73], v14 offset:57600
    ds_read_b64_tr_b16 v[74:75], v14 offset:58368
    ds_read_b64_tr_b16 v[76:77], v14 offset:57664
    v_mfma_f32_32x32x16_bf16 v[40:55], v[88:91], v[164:167], v[40:55]
    ds_read_b64_tr_b16 v[78:79], v14 offset:58432
    ds_read_b64_tr_b16 v[80:81], v14 offset:57728
    buffer_load_dwordx4 v[252:255], v1, s[32:35], s14 offen offset:3072 sc1
    s_add_u32 s14, s14, 4096
    ds_read_b64_tr_b16 v[82:83], v14 offset:58496
    v_mfma_f32_32x32x16_bf16 v[56:71], v[92:95], v[164:167], v[56:71]
    v_add_u32 v134, 124928, v134
    s_lshl_b32 s17, s3, 9
    v_add_u32 v136, s17, v135
    v_mfma_f32_4x4x4_16b_bf16 v[120:123], v[132:133], v[96:97], 0
    v_mfma_f32_4x4x4_16b_bf16 v[124:127], v[132:133], v[100:101], 0
    v_mfma_f32_4x4x4_16b_bf16 v[128:131], v[132:133], v[104:105], 0
    v_mfma_f32_4x4x4_16b_bf16 v[120:123], v[132:133], v[98:99], v[120:123]
    v_mfma_f32_4x4x4_16b_bf16 v[124:127], v[132:133], v[102:103], v[124:127]
    v_mfma_f32_4x4x4_16b_bf16 v[128:131], v[132:133], v[106:107], v[128:131]
    s_waitcnt lgkmcnt(0)
    s_waitcnt vmcnt(21)
    v_mfma_f32_32x32x16_bf16 v[24:39], v[72:75], v[168:171], v[24:39]
    buffer_load_dwordx2 v[4:5], v19, s[32:35], s15 offen offset:0 sc1
    ds_read_b64_tr_b16 v[84:85], v16 offset:49152
    ds_read_b64_tr_b16 v[86:87], v16 offset:52992
    ds_read_b64_tr_b16 v[88:89], v16 offset:49216
    v_mfma_f32_32x32x16_bf16 v[40:55], v[76:79], v[168:171], v[40:55]
    ds_read_b64_tr_b16 v[90:91], v16 offset:53056
    ds_read_b64_tr_b16 v[92:93], v16 offset:49280
    ds_read_b64_tr_b16 v[94:95], v16 offset:53120
    buffer_load_dwordx2 v[6:7], v19, s[32:35], s15 offen offset:1024 sc1
    v_mfma_f32_32x32x16_bf16 v[56:71], v[80:83], v[168:171], v[56:71]
    v_mfma_f32_4x4x4_16b_bf16 v[120:123], v[132:133], v[108:109], v[120:123]
    v_mfma_f32_4x4x4_16b_bf16 v[124:127], v[132:133], v[112:113], v[124:127]
    v_mfma_f32_4x4x4_16b_bf16 v[128:131], v[132:133], v[116:117], v[128:131]
    v_mfma_f32_4x4x4_16b_bf16 v[120:123], v[132:133], v[110:111], v[120:123]
    v_mfma_f32_4x4x4_16b_bf16 v[124:127], v[132:133], v[114:115], v[124:127]
    v_mfma_f32_4x4x4_16b_bf16 v[128:131], v[132:133], v[118:119], v[128:131]
    s_waitcnt lgkmcnt(0)
    s_waitcnt vmcnt(22)
    v_mfma_f32_32x32x16_bf16 v[24:39], v[84:87], v[172:175], v[24:39]
    buffer_load_dwordx2 v[8:9], v19, s[32:35], s15 offen offset:2048 sc1
    ds_read_b64_tr_b16 v[72:73], v15 offset:0
    ds_read_b64_tr_b16 v[74:75], v15 offset:768
    ds_read_b64_tr_b16 v[76:77], v15 offset:64
    v_mfma_f32_32x32x16_bf16 v[40:55], v[88:91], v[172:175], v[40:55]
    ds_read_b64_tr_b16 v[78:79], v15 offset:832
    ds_read_b64_tr_b16 v[80:81], v15 offset:128
    ds_read_b64_tr_b16 v[82:83], v15 offset:896
    v_mfma_f32_32x32x16_bf16 v[56:71], v[92:95], v[172:175], v[56:71]
    buffer_load_dwordx2 v[10:11], v19, s[32:35], s15 offen offset:3072 sc1
    v_add_f32 v120, v120, v3
    v_add_f32 v124, v124, v20
    v_add_f32 v128, v128, v21
    s_waitcnt lgkmcnt(0)
    s_waitcnt vmcnt(23)
    v_mfma_f32_32x32x16_bf16 v[24:39], v[72:75], v[176:179], v[24:39]
    ds_read_b64_tr_b16 v[84:85], v15 offset:3840
    s_add_u32 s69, s68, 24576
    buffer_load_dwordx4 a[96:99], v1, s[32:35], s69 offen offset:0 sc1
    ds_read_b64_tr_b16 v[86:87], v15 offset:4608
    ds_read_b64_tr_b16 v[88:89], v15 offset:3904
    v_mfma_f32_32x32x16_bf16 v[40:55], v[76:79], v[176:179], v[40:55]
    ds_read_b64_tr_b16 v[90:91], v15 offset:4672
    ds_read_b64_tr_b16 v[92:93], v15 offset:3968
    ds_read_b64_tr_b16 v[94:95], v15 offset:4736
    v_mfma_f32_32x32x16_bf16 v[56:71], v[80:83], v[176:179], v[56:71]
    buffer_load_dwordx4 a[100:103], v1, s[32:35], s69 offen offset:1024 sc1
    v_mov_b32 v121, v120
    s_nop 1
    v_permlane32_swap_b32 v120, v121
    v_add_f32 v120, v120, v121
    v_mov_b32 v125, v124
    s_nop 1
    v_permlane32_swap_b32 v124, v125
    v_add_f32 v124, v124, v125
    s_waitcnt lgkmcnt(0)
    s_waitcnt vmcnt(24)
    v_mfma_f32_32x32x16_bf16 v[24:39], v[84:87], v[180:183], v[24:39]
    buffer_load_dwordx4 a[104:107], v1, s[32:35], s69 offen offset:2048 sc1
    ds_read_b64_tr_b16 v[72:73], v15 offset:7680
    ds_read_b64_tr_b16 v[74:75], v15 offset:8448
    ds_read_b64_tr_b16 v[76:77], v15 offset:7744
    v_mfma_f32_32x32x16_bf16 v[40:55], v[88:91], v[180:183], v[40:55]
    ds_read_b64_tr_b16 v[78:79], v15 offset:8512
    ds_read_b64_tr_b16 v[80:81], v15 offset:7808
    ds_read_b64_tr_b16 v[82:83], v15 offset:8576
    v_mfma_f32_32x32x16_bf16 v[56:71], v[92:95], v[180:183], v[56:71]
    buffer_load_dwordx4 a[108:111], v1, s[32:35], s69 offen offset:3072 sc1
    v_mov_b32 v129, v128
    s_nop 1
    v_permlane32_swap_b32 v128, v129
    v_add_f32 v128, v128, v129
    v_mov_b32 v121, v124
    v_mov_b32 v122, v128
    ds_write_b128 v136, v[120:123]
    s_waitcnt lgkmcnt(1)
    s_waitcnt vmcnt(25)
    v_mfma_f32_32x32x16_bf16 v[24:39], v[72:75], v[184:187], v[24:39]
    s_add_u32 s69, s68, 28672
    buffer_load_dwordx4 a[112:115], v1, s[32:35], s69 offen offset:0 sc1
    ds_read_b64_tr_b16 v[84:85], v15 offset:11520
    ds_read_b64_tr_b16 v[86:87], v15 offset:12288
    ds_read_b64_tr_b16 v[88:89], v15 offset:11584
    v_mfma_f32_32x32x16_bf16 v[40:55], v[76:79], v[184:187], v[40:55]
    ds_read_b64_tr_b16 v[90:91], v15 offset:12352
    buffer_load_dwordx4 a[116:119], v1, s[32:35], s69 offen offset:1024 sc1
    ds_read_b64_tr_b16 v[92:93], v15 offset:11648
    ds_read_b64_tr_b16 v[94:95], v15 offset:12416
    v_mfma_f32_32x32x16_bf16 v[56:71], v[80:83], v[184:187], v[56:71]
    s_waitcnt lgkmcnt(6)
    s_barrier
    s_waitcnt lgkmcnt(0)
    s_waitcnt vmcnt(26)
    v_mfma_f32_32x32x16_bf16 v[24:39], v[84:87], v[188:191], v[24:39]
    buffer_load_dwordx4 a[120:123], v1, s[32:35], s69 offen offset:2048 sc1
    ds_read_b64_tr_b16 v[72:73], v17 offset:3072
    ds_read_b64_tr_b16 v[74:75], v17 offset:6912
    ds_read_b64_tr_b16 v[76:77], v17 offset:3136
    v_mfma_f32_32x32x16_bf16 v[40:55], v[88:91], v[188:191], v[40:55]
    ds_read_b64_tr_b16 v[78:79], v17 offset:6976
    ds_read_b64_tr_b16 v[80:81], v17 offset:3200
    ds_read_b64_tr_b16 v[82:83], v17 offset:7040
    buffer_load_dwordx4 a[124:127], v1, s[32:35], s69 offen offset:3072 sc1
    v_mfma_f32_32x32x16_bf16 v[56:71], v[92:95], v[188:191], v[56:71]
    ds_read_b128 v[96:99], v135 offset:0
    ds_read_b128 v[100:103], v135 offset:512
    ds_read_b128 v[104:107], v135 offset:1024
    ds_read_b128 v[108:111], v135 offset:1536
    s_waitcnt lgkmcnt(4)
    s_waitcnt vmcnt(27)
    v_mfma_f32_32x32x16_bf16 v[24:39], v[72:75], v[192:195], v[24:39]
    s_add_u32 s69, s68, 32768
    buffer_load_dwordx4 a[128:131], v1, s[32:35], s69 offen offset:0 sc1
    ds_read_b64_tr_b16 v[84:85], v15 offset:15360
    ds_read_b64_tr_b16 v[86:87], v15 offset:16128
    ds_read_b64_tr_b16 v[88:89], v15 offset:15424
    v_mfma_f32_32x32x16_bf16 v[40:55], v[76:79], v[192:195], v[40:55]
    ds_read_b64_tr_b16 v[90:91], v15 offset:16192
    ds_read_b64_tr_b16 v[92:93], v15 offset:15488
    ds_read_b64_tr_b16 v[94:95], v15 offset:16256
    buffer_load_dwordx4 a[132:135], v1, s[32:35], s69 offen offset:1024 sc1
    v_mfma_f32_32x32x16_bf16 v[56:71], v[80:83], v[192:195], v[56:71]
    s_waitcnt lgkmcnt(0)
    s_waitcnt vmcnt(28)
    v_mfma_f32_32x32x16_bf16 v[24:39], v[84:87], v[196:199], v[24:39]
    buffer_load_dwordx4 a[136:139], v1, s[32:35], s69 offen offset:2048 sc1
    ds_read_b64_tr_b16 v[72:73], v15 offset:19200
    ds_read_b64_tr_b16 v[74:75], v15 offset:19968
    ds_read_b64_tr_b16 v[76:77], v15 offset:19264
    v_mfma_f32_32x32x16_bf16 v[40:55], v[88:91], v[196:199], v[40:55]
    ds_read_b64_tr_b16 v[78:79], v15 offset:20032
    ds_read_b64_tr_b16 v[80:81], v15 offset:19328
    ds_read_b64_tr_b16 v[82:83], v15 offset:20096
    v_mfma_f32_32x32x16_bf16 v[56:71], v[92:95], v[196:199], v[56:71]
    buffer_load_dwordx4 a[140:143], v1, s[32:35], s69 offen offset:3072 sc1
    v_pk_add_f32 v[96:97], v[96:97], v[100:101]
    v_add_f32 v98, v98, v102
    v_pk_add_f32 v[104:105], v[104:105], v[108:109]
    v_add_f32 v106, v106, v110
    v_pk_add_f32 v[96:97], v[96:97], v[104:105]
    v_add_f32 v98, v98, v106
    s_waitcnt lgkmcnt(0)
    s_waitcnt vmcnt(29)
    v_mfma_f32_32x32x16_bf16 v[24:39], v[72:75], v[200:203], v[24:39]
    s_add_u32 s69, s68, 36864
    buffer_load_dwordx4 a[144:147], v1, s[32:35], s69 offen offset:0 sc1
    ds_read_b64_tr_b16 v[84:85], v15 offset:23040
    ds_read_b64_tr_b16 v[86:87], v15 offset:23808
    ds_read_b64_tr_b16 v[88:89], v15 offset:23104
    v_mfma_f32_32x32x16_bf16 v[40:55], v[76:79], v[200:203], v[40:55]
    ds_read_b64_tr_b16 v[90:91], v15 offset:23872
    ds_read_b64_tr_b16 v[92:93], v15 offset:23168
    ds_read_b64_tr_b16 v[94:95], v15 offset:23936
    v_mfma_f32_32x32x16_bf16 v[56:71], v[80:83], v[200:203], v[56:71]
    buffer_load_dwordx4 a[148:151], v1, s[32:35], s69 offen offset:1024 sc1
    ds_write_b32 v134, v96 offset:0
    ds_write_b32 v134, v97 offset:128
    ds_write_b32 v134, v98 offset:256
    s_waitcnt lgkmcnt(3)
    s_waitcnt vmcnt(30)
    v_mfma_f32_32x32x16_bf16 v[24:39], v[84:87], v[204:207], v[24:39]
    buffer_load_dwordx4 a[152:155], v1, s[32:35], s69 offen offset:2048 sc1
    ds_read_b64_tr_b16 v[72:73], v15 offset:26880
    ds_read_b64_tr_b16 v[74:75], v15 offset:27648
    ds_read_b64_tr_b16 v[76:77], v15 offset:26944
    v_mfma_f32_32x32x16_bf16 v[40:55], v[88:91], v[204:207], v[40:55]
    ds_read_b64_tr_b16 v[78:79], v15 offset:27712
    ds_read_b64_tr_b16 v[80:81], v15 offset:27008
    ds_read_b64_tr_b16 v[82:83], v15 offset:27776
    v_mfma_f32_32x32x16_bf16 v[56:71], v[92:95], v[204:207], v[56:71]
    buffer_load_dwordx4 a[156:159], v1, s[32:35], s69 offen offset:3072 sc1
    s_waitcnt lgkmcnt(0)
    s_waitcnt vmcnt(31)
    v_mfma_f32_32x32x16_bf16 v[24:39], v[72:75], v[208:211], v[24:39]
    ds_read_b64_tr_b16 v[84:85], v17 offset:18432
    ds_read_b64_tr_b16 v[86:87], v17 offset:22272
    ds_read_b64_tr_b16 v[88:89], v17 offset:18496
    v_mfma_f32_32x32x16_bf16 v[40:55], v[76:79], v[208:211], v[40:55]
    ds_read_b64_tr_b16 v[90:91], v17 offset:22336
    ds_read_b64_tr_b16 v[92:93], v17 offset:18560
    ds_read_b64_tr_b16 v[94:95], v17 offset:22400
    v_mfma_f32_32x32x16_bf16 v[56:71], v[80:83], v[208:211], v[56:71]
    s_waitcnt lgkmcnt(0)
    s_waitcnt vmcnt(30)
    v_mfma_f32_32x32x16_bf16 v[24:39], v[84:87], v[212:215], v[24:39]
    ds_read_b64_tr_b16 v[72:73], v15 offset:30720
    ds_read_b64_tr_b16 v[74:75], v15 offset:31488
    ds_read_b64_tr_b16 v[76:77], v15 offset:30784
    v_mfma_f32_32x32x16_bf16 v[40:55], v[88:91], v[212:215], v[40:55]
    ds_read_b64_tr_b16 v[78:79], v15 offset:31552
    ds_read_b64_tr_b16 v[80:81], v15 offset:30848
    ds_read_b64_tr_b16 v[82:83], v15 offset:31616
    v_mfma_f32_32x32x16_bf16 v[56:71], v[92:95], v[212:215], v[56:71]
    s_waitcnt lgkmcnt(0)
    s_waitcnt vmcnt(29)
    v_mfma_f32_32x32x16_bf16 v[24:39], v[72:75], v[216:219], v[24:39]
    ds_read_b64_tr_b16 v[84:85], v15 offset:34560
    ds_read_b64_tr_b16 v[86:87], v15 offset:35328
    ds_read_b64_tr_b16 v[88:89], v15 offset:34624
    v_mfma_f32_32x32x16_bf16 v[40:55], v[76:79], v[216:219], v[40:55]
    ds_read_b64_tr_b16 v[90:91], v15 offset:35392
    ds_read_b64_tr_b16 v[92:93], v15 offset:34688
    ds_read_b64_tr_b16 v[94:95], v15 offset:35456
    v_mfma_f32_32x32x16_bf16 v[56:71], v[80:83], v[216:219], v[56:71]
    s_waitcnt lgkmcnt(0)
    s_waitcnt vmcnt(28)
    v_mfma_f32_32x32x16_bf16 v[24:39], v[84:87], v[220:223], v[24:39]
    ds_read_b64_tr_b16 v[72:73], v15 offset:38400
    ds_read_b64_tr_b16 v[74:75], v15 offset:39168
    ds_read_b64_tr_b16 v[76:77], v15 offset:38464
    v_mfma_f32_32x32x16_bf16 v[40:55], v[88:91], v[220:223], v[40:55]
    ds_read_b64_tr_b16 v[78:79], v15 offset:39232
    ds_read_b64_tr_b16 v[80:81], v15 offset:38528
    ds_read_b64_tr_b16 v[82:83], v15 offset:39296
    v_mfma_f32_32x32x16_bf16 v[56:71], v[92:95], v[220:223], v[56:71]
    s_waitcnt lgkmcnt(0)
    s_waitcnt vmcnt(27)
    v_mfma_f32_32x32x16_bf16 v[24:39], v[72:75], v[224:227], v[24:39]
    ds_read_b64_tr_b16 v[84:85], v15 offset:42240
    ds_read_b64_tr_b16 v[86:87], v15 offset:43008
    ds_read_b64_tr_b16 v[88:89], v15 offset:42304
    v_mfma_f32_32x32x16_bf16 v[40:55], v[76:79], v[224:227], v[40:55]
    ds_read_b64_tr_b16 v[90:91], v15 offset:43072
    ds_read_b64_tr_b16 v[92:93], v15 offset:42368
    ds_read_b64_tr_b16 v[94:95], v15 offset:43136
    v_mfma_f32_32x32x16_bf16 v[56:71], v[80:83], v[224:227], v[56:71]
    s_waitcnt lgkmcnt(0)
    s_waitcnt vmcnt(26)
    v_mfma_f32_32x32x16_bf16 v[24:39], v[84:87], v[228:231], v[24:39]
    ds_read_b64_tr_b16 v[72:73], v17 offset:33792
    ds_read_b64_tr_b16 v[74:75], v17 offset:37632
    ds_read_b64_tr_b16 v[76:77], v17 offset:33856
    v_mfma_f32_32x32x16_bf16 v[40:55], v[88:91], v[228:231], v[40:55]
    ds_read_b64_tr_b16 v[78:79], v17 offset:37696
    ds_read_b64_tr_b16 v[80:81], v17 offset:33920
    ds_read_b64_tr_b16 v[82:83], v17 offset:37760
    v_mfma_f32_32x32x16_bf16 v[56:71], v[92:95], v[228:231], v[56:71]
    s_waitcnt vmcnt(16)
    v_pk_add_f32 v[4:5], v[4:5], v[6:7]
    v_pk_add_f32 v[8:9], v[8:9], v[10:11]
    v_pk_add_f32 v[4:5], v[4:5], v[8:9]
    s_waitcnt lgkmcnt(0)
    v_mfma_f32_32x32x16_bf16 v[24:39], v[72:75], v[232:235], v[24:39]
    ds_read_b64_tr_b16 v[84:85], v15 offset:46080
    ds_read_b64_tr_b16 v[86:87], v15 offset:46848
    ds_read_b64_tr_b16 v[88:89], v15 offset:46144
    v_mfma_f32_32x32x16_bf16 v[40:55], v[76:79], v[232:235], v[40:55]
    ds_read_b64_tr_b16 v[90:91], v15 offset:46912
    ds_read_b64_tr_b16 v[92:93], v15 offset:46208
    ds_read_b64_tr_b16 v[94:95], v15 offset:46976
    v_mfma_f32_32x32x16_bf16 v[56:71], v[80:83], v[232:235], v[56:71]
    v_mov_b32 v6, v4
    v_mov_b32 v7, v5
    s_nop 0
    v_permlane32_swap_b32 v4, v6
    v_permlane32_swap_b32 v5, v7
    v_pk_add_f32 v[4:5], v[4:5], v[6:7]
    s_waitcnt lgkmcnt(0)
    v_mfma_f32_32x32x16_bf16 v[24:39], v[84:87], v[236:239], v[24:39]
    ds_read_b64_tr_b16 v[72:73], v15 offset:49920
    ds_read_b64_tr_b16 v[74:75], v15 offset:50688
    ds_read_b64_tr_b16 v[76:77], v15 offset:49984
    v_mfma_f32_32x32x16_bf16 v[40:55], v[88:91], v[236:239], v[40:55]
    ds_read_b64_tr_b16 v[78:79], v15 offset:50752
    ds_read_b64_tr_b16 v[80:81], v15 offset:50048
    ds_read_b64_tr_b16 v[82:83], v15 offset:50816
    v_mfma_f32_32x32x16_bf16 v[56:71], v[92:95], v[236:239], v[56:71]
    v_mul_f32 v6, 0xbacccccd, v4
    v_mul_f32 v10, 0x3acccccd, v5
    v_fma_f32 v10, -v6, v6, v10
    v_max_f32 v10, 0, v10
    v_add_f32 v10, 0x3727c5ac, v10
    v_rsq_f32 v8, v10
    s_waitcnt lgkmcnt(0)
    v_mfma_f32_32x32x16_bf16 v[24:39], v[72:75], v[240:243], v[24:39]
    ds_read_b64_tr_b16 v[84:85], v15 offset:53760
    ds_read_b64_tr_b16 v[86:87], v15 offset:54528
    ds_read_b64_tr_b16 v[88:89], v15 offset:53824
    v_mfma_f32_32x32x16_bf16 v[40:55], v[76:79], v[240:243], v[40:55]
    ds_read_b64_tr_b16 v[90:91], v15 offset:54592
    ds_read_b64_tr_b16 v[92:93], v15 offset:53888
    ds_read_b64_tr_b16 v[94:95], v15 offset:54656
    v_mfma_f32_32x32x16_bf16 v[56:71], v[80:83], v[240:243], v[56:71]
    ds_read_b128 v[96:99], v22 offset:0
    ds_read_b128 v[100:103], v22 offset:32
    ds_read_b128 v[104:107], v22 offset:64
    ds_read_b128 v[108:111], v22 offset:96
    s_waitcnt lgkmcnt(4)
    v_mfma_f32_32x32x16_bf16 v[24:39], v[84:87], v[244:247], v[24:39]
    ds_read_b64_tr_b16 v[72:73], v15 offset:57600
    ds_read_b64_tr_b16 v[74:75], v15 offset:58368
    ds_read_b64_tr_b16 v[76:77], v15 offset:57664
    v_mfma_f32_32x32x16_bf16 v[40:55], v[88:91], v[244:247], v[40:55]
    ds_read_b64_tr_b16 v[78:79], v15 offset:58432
    ds_read_b64_tr_b16 v[80:81], v15 offset:57728
    ds_read_b64_tr_b16 v[82:83], v15 offset:58496
    v_mfma_f32_32x32x16_bf16 v[56:71], v[92:95], v[244:247], v[56:71]
    ds_read_b128 v[112:115], v22 offset:128
    ds_read_b128 v[116:119], v22 offset:160
    ds_read_b128 v[120:123], v22 offset:192
    ds_read_b128 v[124:127], v22 offset:224
    s_waitcnt lgkmcnt(4)
    v_mfma_f32_32x32x16_bf16 v[24:39], v[72:75], v[248:251], v[24:39]
    ds_read_b64_tr_b16 v[84:85], v17 offset:49152
    ds_read_b64_tr_b16 v[86:87], v17 offset:52992
    ds_read_b64_tr_b16 v[88:89], v17 offset:49216
    v_mfma_f32_32x32x16_bf16 v[40:55], v[76:79], v[248:251], v[40:55]
    ds_read_b64_tr_b16 v[90:91], v17 offset:53056
    ds_read_b64_tr_b16 v[92:93], v17 offset:49280
    ds_read_b64_tr_b16 v[94:95], v17 offset:53120
    v_mfma_f32_32x32x16_bf16 v[56:71], v[80:83], v[248:251], v[56:71]
    ds_read_b128 v[128:131], v22 offset:256
    ds_read_b128 v[132:135], v22 offset:288
    ds_read_b128 v[136:139], v22 offset:320
    ds_read_b128 v[140:143], v22 offset:352
    s_waitcnt lgkmcnt(4)
    v_mfma_f32_32x32x16_bf16 v[24:39], v[84:87], v[252:255], v[24:39]
    v_mfma_f32_32x32x16_bf16 v[40:55], v[88:91], v[252:255], v[40:55]
    v_mfma_f32_32x32x16_bf16 v[56:71], v[92:95], v[252:255], v[56:71]
    s_mul_i32 s16, s1, 393216
    s_mul_i32 s17, s3, 98304
    s_add_u32 s16, s16, s17
    s_mul_i32 s17, s9, 3072
    s_add_u32 s16, s16, s17
    s_add_u32 s16, s16, 8388608
    s_lshr_b32 s13, s3, 1
    s_lshl1_add_u32 s13, s1, s13
    s_lshr_b32 s17, s9, 2
    s_lshl2_add_u32 s13, s13, s17
    s_add_u32 s13, s13, 256
    s_lshl_b32 s13, s13, 7
    s_waitcnt lgkmcnt(0)
    v_pk_fma_f32 v[24:25], v[96:97], v[6:7], v[24:25] op_sel_hi:[1,0,1]
    v_pk_fma_f32 v[26:27], v[98:99], v[6:7], v[26:27] op_sel_hi:[1,0,1]
    v_pk_fma_f32 v[28:29], v[100:101], v[6:7], v[28:29] op_sel_hi:[1,0,1]
    v_pk_fma_f32 v[30:31], v[102:103], v[6:7], v[30:31] op_sel_hi:[1,0,1]
    v_pk_fma_f32 v[32:33], v[104:105], v[6:7], v[32:33] op_sel_hi:[1,0,1]
    v_pk_fma_f32 v[34:35], v[106:107], v[6:7], v[34:35] op_sel_hi:[1,0,1]
    v_pk_fma_f32 v[36:37], v[108:109], v[6:7], v[36:37] op_sel_hi:[1,0,1]
    v_pk_fma_f32 v[38:39], v[110:111], v[6:7], v[38:39] op_sel_hi:[1,0,1]
    v_pk_mul_f32 v[24:25], v[24:25], v[8:9] op_sel_hi:[1,0]
    v_pk_mul_f32 v[26:27], v[26:27], v[8:9] op_sel_hi:[1,0]
    v_pk_mul_f32 v[28:29], v[28:29], v[8:9] op_sel_hi:[1,0]
    v_pk_mul_f32 v[30:31], v[30:31], v[8:9] op_sel_hi:[1,0]
    v_pk_mul_f32 v[32:33], v[32:33], v[8:9] op_sel_hi:[1,0]
    v_pk_mul_f32 v[34:35], v[34:35], v[8:9] op_sel_hi:[1,0]
    v_pk_mul_f32 v[36:37], v[36:37], v[8:9] op_sel_hi:[1,0]
    v_pk_mul_f32 v[38:39], v[38:39], v[8:9] op_sel_hi:[1,0]
    v_cvt_pk_bf16_f32 v144, v24, v25
    v_cvt_pk_bf16_f32 v145, v26, v27
    v_cvt_pk_bf16_f32 v146, v28, v29
    v_cvt_pk_bf16_f32 v147, v30, v31
    v_cvt_pk_bf16_f32 v148, v32, v33
    v_cvt_pk_bf16_f32 v149, v34, v35
    v_cvt_pk_bf16_f32 v150, v36, v37
    v_cvt_pk_bf16_f32 v151, v38, v39
    v_pk_max_i16 v144, v144, 0
    v_pk_max_i16 v145, v145, 0
    v_pk_max_i16 v146, v146, 0
    v_pk_max_i16 v147, v147, 0
    v_pk_max_i16 v148, v148, 0
    v_pk_max_i16 v149, v149, 0
    v_pk_max_i16 v150, v150, 0
    v_pk_max_i16 v151, v151, 0
    buffer_store_dwordx4 v[144:147], v23, s[32:35], s16 offen offset:0 sc1
    buffer_store_dwordx4 v[148:151], v23, s[32:35], s16 offen offset:512 sc1
    v_pk_fma_f32 v[40:41], v[112:113], v[6:7], v[40:41] op_sel_hi:[1,0,1]
    v_pk_fma_f32 v[42:43], v[114:115], v[6:7], v[42:43] op_sel_hi:[1,0,1]
    v_pk_fma_f32 v[44:45], v[116:117], v[6:7], v[44:45] op_sel_hi:[1,0,1]
    v_pk_fma_f32 v[46:47], v[118:119], v[6:7], v[46:47] op_sel_hi:[1,0,1]
    v_pk_fma_f32 v[48:49], v[120:121], v[6:7], v[48:49] op_sel_hi:[1,0,1]
    v_pk_fma_f32 v[50:51], v[122:123], v[6:7], v[50:51] op_sel_hi:[1,0,1]
    v_pk_fma_f32 v[52:53], v[124:125], v[6:7], v[52:53] op_sel_hi:[1,0,1]
    v_pk_fma_f32 v[54:55], v[126:127], v[6:7], v[54:55] op_sel_hi:[1,0,1]
    v_pk_mul_f32 v[40:41], v[40:41], v[8:9] op_sel_hi:[1,0]
    v_pk_mul_f32 v[42:43], v[42:43], v[8:9] op_sel_hi:[1,0]
    v_pk_mul_f32 v[44:45], v[44:45], v[8:9] op_sel_hi:[1,0]
    v_pk_mul_f32 v[46:47], v[46:47], v[8:9] op_sel_hi:[1,0]
    v_pk_mul_f32 v[48:49], v[48:49], v[8:9] op_sel_hi:[1,0]
    v_pk_mul_f32 v[50:51], v[50:51], v[8:9] op_sel_hi:[1,0]
    v_pk_mul_f32 v[52:53], v[52:53], v[8:9] op_sel_hi:[1,0]
    v_pk_mul_f32 v[54:55], v[54:55], v[8:9] op_sel_hi:[1,0]
    v_cvt_pk_bf16_f32 v152, v40, v41
    v_cvt_pk_bf16_f32 v153, v42, v43
    v_cvt_pk_bf16_f32 v154, v44, v45
    v_cvt_pk_bf16_f32 v155, v46, v47
    v_cvt_pk_bf16_f32 v156, v48, v49
    v_cvt_pk_bf16_f32 v157, v50, v51
    v_cvt_pk_bf16_f32 v158, v52, v53
    v_cvt_pk_bf16_f32 v159, v54, v55
    v_pk_max_i16 v152, v152, 0
    v_pk_max_i16 v153, v153, 0
    v_pk_max_i16 v154, v154, 0
    v_pk_max_i16 v155, v155, 0
    v_pk_max_i16 v156, v156, 0
    v_pk_max_i16 v157, v157, 0
    v_pk_max_i16 v158, v158, 0
    v_pk_max_i16 v159, v159, 0
    buffer_store_dwordx4 v[152:155], v23, s[32:35], s16 offen offset:1024 sc1
    buffer_store_dwordx4 v[156:159], v23, s[32:35], s16 offen offset:1536 sc1
    v_pk_fma_f32 v[56:57], v[128:129], v[6:7], v[56:57] op_sel_hi:[1,0,1]
    v_pk_fma_f32 v[58:59], v[130:131], v[6:7], v[58:59] op_sel_hi:[1,0,1]
    v_pk_fma_f32 v[60:61], v[132:133], v[6:7], v[60:61] op_sel_hi:[1,0,1]
    v_pk_fma_f32 v[62:63], v[134:135], v[6:7], v[62:63] op_sel_hi:[1,0,1]
    v_pk_fma_f32 v[64:65], v[136:137], v[6:7], v[64:65] op_sel_hi:[1,0,1]
    v_pk_fma_f32 v[66:67], v[138:139], v[6:7], v[66:67] op_sel_hi:[1,0,1]
    v_pk_fma_f32 v[68:69], v[140:141], v[6:7], v[68:69] op_sel_hi:[1,0,1]
    v_pk_fma_f32 v[70:71], v[142:143], v[6:7], v[70:71] op_sel_hi:[1,0,1]
    v_pk_mul_f32 v[56:57], v[56:57], v[8:9] op_sel_hi:[1,0]
    v_pk_mul_f32 v[58:59], v[58:59], v[8:9] op_sel_hi:[1,0]
    v_pk_mul_f32 v[60:61], v[60:61], v[8:9] op_sel_hi:[1,0]
    v_pk_mul_f32 v[62:63], v[62:63], v[8:9] op_sel_hi:[1,0]
    v_pk_mul_f32 v[64:65], v[64:65], v[8:9] op_sel_hi:[1,0]
    v_pk_mul_f32 v[66:67], v[66:67], v[8:9] op_sel_hi:[1,0]
    v_pk_mul_f32 v[68:69], v[68:69], v[8:9] op_sel_hi:[1,0]
    v_pk_mul_f32 v[70:71], v[70:71], v[8:9] op_sel_hi:[1,0]
    v_cvt_pk_bf16_f32 v160, v56, v57
    v_cvt_pk_bf16_f32 v161, v58, v59
    v_cvt_pk_bf16_f32 v162, v60, v61
    v_cvt_pk_bf16_f32 v163, v62, v63
    v_cvt_pk_bf16_f32 v164, v64, v65
    v_cvt_pk_bf16_f32 v165, v66, v67
    v_cvt_pk_bf16_f32 v166, v68, v69
    v_cvt_pk_bf16_f32 v167, v70, v71
    v_pk_max_i16 v160, v160, 0
    v_pk_max_i16 v161, v161, 0
    v_pk_max_i16 v162, v162, 0
    v_pk_max_i16 v163, v163, 0
    v_pk_max_i16 v164, v164, 0
    v_pk_max_i16 v165, v165, 0
    v_pk_max_i16 v166, v166, 0
    v_pk_max_i16 v167, v167, 0
    buffer_store_dwordx4 v[160:163], v23, s[32:35], s16 offen offset:2048 sc1
    buffer_store_dwordx4 v[164:167], v23, s[32:35], s16 offen offset:2560 sc1
    s_add_u32 s69, s68, 40960
    buffer_load_dwordx4 a[160:163], v1, s[32:35], s69 offen offset:0 sc1
    buffer_load_dwordx4 a[164:167], v1, s[32:35], s69 offen offset:1024 sc1
    buffer_load_dwordx4 a[168:171], v1, s[32:35], s69 offen offset:2048 sc1
    buffer_load_dwordx4 a[172:175], v1, s[32:35], s69 offen offset:3072 sc1
    s_add_u32 s69, s68, 45056
    buffer_load_dwordx4 a[176:179], v1, s[32:35], s69 offen offset:0 sc1
    buffer_load_dwordx4 a[180:183], v1, s[32:35], s69 offen offset:1024 sc1
    buffer_load_dwordx4 a[184:187], v1, s[32:35], s69 offen offset:2048 sc1
    buffer_load_dwordx4 a[188:191], v1, s[32:35], s69 offen offset:3072 sc1
    s_add_u32 s69, s68, 49152
    buffer_load_dwordx4 a[192:195], v1, s[32:35], s69 offen offset:0 sc1
    buffer_load_dwordx4 a[196:199], v1, s[32:35], s69 offen offset:1024 sc1
    s_lshl1_add_u32 s12, s6, s7
    s_lshl2_add_u32 s12, s12, s3
    s_add_u32 s12, s12, 256
    s_lshl_b32 s12, s12, 7
    s_mul_i32 s14, s6, 393216
    s_mul_i32 s15, s7, 196608
    s_add_u32 s14, s14, s15
    s_mul_i32 s15, s3, 12288
    s_add_u32 s14, s14, s15
    s_add_u32 s14, s14, 8388608
    s_add_u32 s15, s3, 1
    s_and_b32 s15, s15, 3
    s_mul_i32 s16, s15, 49152
    s_add_u32 s16, s16, s14
    s_mul_i32 s15, s15, 15360
    s_add_u32 s15, s15, 0
    v_add_u32 v14, s15, v1
    s_add_u32 s15, s3, 2
    s_and_b32 s15, s15, 3
    s_mul_i32 s17, s15, 49152
    s_add_u32 s17, s17, s14
    s_mul_i32 s15, s15, 15360
    s_add_u32 s15, s15, 5120
    v_add_u32 v15, s15, v1
    s_add_u32 s15, s3, 3
    s_and_b32 s15, s15, 3
    s_mul_i32 s18, s15, 49152
    s_add_u32 s18, s18, s14
    s_mul_i32 s15, s15, 15360
    s_add_u32 s15, s15, 10240
    v_add_u32 v16, s15, v1
    s_add_u32 s15, s3, 4
    s_and_b32 s15, s15, 3
    s_mul_i32 s19, s15, 49152
    s_add_u32 s19, s19, s14
    s_mul_i32 s15, s15, 15360
    s_add_u32 s15, s15, 0
    v_add_u32 v17, s15, v1
    v_add_u32 v18, 4096, v1
    v_add_u32 v19, 8192, v1
    s_lshr_b32 s15, s8, 1
    s_mul_i32 s20, s15, 49152
    s_and_b32 s15, s8, 1
    s_mul_i32 s15, s15, 6144
    s_add_u32 s20, s20, s15
    s_add_u32 s20, s20, s14
    s_barrier
    s_waitcnt vmcnt(10)
    s_mov_b32 s65, 1
    s_atomic_add s65, s[32:33], s13
    buffer_load_dwordx4 a[200:203], v1, s[32:35], s69 offen offset:2048 sc1
    buffer_load_dwordx4 a[204:207], v1, s[32:35], s69 offen offset:3072 sc1
    s_add_u32 s69, s68, 53248
    buffer_load_dwordx4 a[208:211], v1, s[32:35], s69 offen offset:0 sc1
    buffer_load_dwordx4 a[212:215], v1, s[32:35], s69 offen offset:1024 sc1
    buffer_load_dwordx4 a[216:219], v1, s[32:35], s69 offen offset:2048 sc1
    buffer_load_dwordx4 a[220:223], v1, s[32:35], s69 offen offset:3072 sc1
    s_add_u32 s69, s68, 57344
    buffer_load_dwordx4 a[224:227], v1, s[32:35], s69 offen offset:0 sc1
    buffer_load_dwordx4 a[228:231], v1, s[32:35], s69 offen offset:1024 sc1
    buffer_load_dwordx4 a[232:235], v1, s[32:35], s69 offen offset:2048 sc1
    buffer_load_dwordx4 a[236:239], v1, s[32:35], s69 offen offset:3072 sc1
    s_mov_b32 s66, 0
L_poll_18:
    s_mov_b32 s62, 0
    s_atomic_add s62, s[32:33], s12 glc
    s_add_u32 s66, s66, 1
    s_cmp_ge_u32 s66, 40000
    s_waitcnt lgkmcnt(0)
    s_cbranch_scc1 L_polled_19
    s_cmp_lt_u32 s62, 8
    s_cbranch_scc1 L_poll_18
L_polled_19:
    buffer_load_dwordx4 v[64:67], v1, s[32:35], s16 offen offset:0 sc1
    buffer_load_dwordx4 v[68:71], v1, s[32:35], s16 offen offset:1024 sc1
    buffer_load_dwordx4 v[72:75], v1, s[32:35], s16 offen offset:2048 sc1
    buffer_load_dwordx4 v[76:79], v1, s[32:35], s16 offen offset:3072 sc1
    buffer_load_dwordx4 v[80:83], v18, s[32:35], s16 offen offset:0 sc1
    buffer_load_dwordx4 v[84:87], v18, s[32:35], s16 offen offset:1024 sc1
    s_waitcnt vmcnt(5)
    v_mfma_f32_16x16x32_bf16 v[24:27], a[0:3], v[64:67], 0
    buffer_load_dwordx4 v[88:91], v18, s[32:35], s16 offen offset:2048 sc1
    v_mfma_f32_16x16x32_bf16 v[28:31], a[4:7], v[64:67], 0
    buffer_load_dwordx4 v[92:95], v18, s[32:35], s16 offen offset:3072 sc1
    v_mfma_f32_16x16x32_bf16 v[32:35], a[8:11], v[64:67], 0
    v_mfma_f32_16x16x32_bf16 v[36:39], a[12:15], v[64:67], 0
    v_mfma_f32_16x16x32_bf16 v[40:43], a[16:19], v[64:67], 0
    s_waitcnt vmcnt(6)
    v_mfma_f32_16x16x32_bf16 v[24:27], a[20:23], v[68:71], v[24:27]
    buffer_load_dwordx4 v[96:99], v19, s[32:35], s16 offen offset:0 sc1
    v_mfma_f32_16x16x32_bf16 v[28:31], a[24:27], v[68:71], v[28:31]
    v_mfma_f32_16x16x32_bf16 v[32:35], a[28:31], v[68:71], v[32:35]
    v_mfma_f32_16x16x32_bf16 v[36:39], a[32:35], v[68:71], v[36:39]
    v_mfma_f32_16x16x32_bf16 v[40:43], a[36:39], v[68:71], v[40:43]
    s_waitcnt vmcnt(6)
    v_mfma_f32_16x16x32_bf16 v[24:27], a[40:43], v[72:75], v[24:27]
    buffer_load_dwordx4 v[100:103], v19, s[32:35], s16 offen offset:1024 sc1
    v_mfma_f32_16x16x32_bf16 v[28:31], a[44:47], v[72:75], v[28:31]
    v_mfma_f32_16x16x32_bf16 v[32:35], a[48:51], v[72:75], v[32:35]
    v_mfma_f32_16x16x32_bf16 v[36:39], a[52:55], v[72:75], v[36:39]
    v_mfma_f32_16x16x32_bf16 v[40:43], a[56:59], v[72:75], v[40:43]
    s_waitcnt vmcnt(6)
    v_mfma_f32_16x16x32_bf16 v[24:27], a[60:63], v[76:79], v[24:27]
    buffer_load_dwordx4 v[104:107], v19, s[32:35], s16 offen offset:2048 sc1
    v_mfma_f32_16x16x32_bf16 v[28:31], a[64:67], v[76:79], v[28:31]
    v_mfma_f32_16x16x32_bf16 v[32:35], a[68:71], v[76:79], v[32:35]
    v_mfma_f32_16x16x32_bf16 v[36:39], a[72:75], v[76:79], v[36:39]
    v_mfma_f32_16x16x32_bf16 v[40:43], a[76:79], v[76:79], v[40:43]
    s_waitcnt vmcnt(6)
    v_mfma_f32_16x16x32_bf16 v[24:27], a[80:83], v[80:83], v[24:27]
    buffer_load_dwordx4 v[108:111], v19, s[32:35], s16 offen offset:3072 sc1
    v_mfma_f32_16x16x32_bf16 v[28:31], a[84:87], v[80:83], v[28:31]
    v_mfma_f32_16x16x32_bf16 v[32:35], a[88:91], v[80:83], v[32:35]
    v_mfma_f32_16x16x32_bf16 v[36:39], a[92:95], v[80:83], v[36:39]
    v_mfma_f32_16x16x32_bf16 v[40:43], a[96:99], v[80:83], v[40:43]
    buffer_load_dwordx4 v[112:115], v1, s[32:35], s17 offen offset:0 sc1
    s_waitcnt vmcnt(7)
    v_mfma_f32_16x16x32_bf16 v[24:27], a[100:103], v[84:87], v[24:27]
    v_mfma_f32_16x16x32_bf16 v[28:31], a[104:107], v[84:87], v[28:31]
    v_mfma_f32_16x16x32_bf16 v[32:35], a[108:111], v[84:87], v[32:35]
    v_mfma_f32_16x16x32_bf16 v[36:39], a[112:115], v[84:87], v[36:39]
    v_mfma_f32_16x16x32_bf16 v[40:43], a[116:119], v[84:87], v[40:43]
    buffer_load_dwordx4 v[116:119], v1, s[32:35], s17 offen offset:1024 sc1
    s_waitcnt vmcnt(7)
    v_mfma_f32_16x16x32_bf16 v[24:27], a[120:123], v[88:91], v[24:27]
    v_mfma_f32_16x16x32_bf16 v[28:31], a[124:127], v[88:91], v[28:31]
    v_mfma_f32_16x16x32_bf16 v[32:35], a[128:131], v[88:91], v[32:35]
    v_mfma_f32_16x16x32_bf16 v[36:39], a[132:135], v[88:91], v[36:39]
    v_mfma_f32_16x16x32_bf16 v[40:43], a[136:139], v[88:91], v[40:43]
    buffer_load_dwordx4 v[120:123], v1, s[32:35], s17 offen offset:2048 sc1
    s_waitcnt vmcnt(7)
    v_mfma_f32_16x16x32_bf16 v[24:27], a[140:143], v[92:95], v[24:27]
    v_mfma_f32_16x16x32_bf16 v[28:31], a[144:147], v[92:95], v[28:31]
    v_mfma_f32_16x16x32_bf16 v[32:35], a[148:151], v[92:95], v[32:35]
    v_mfma_f32_16x16x32_bf16 v[36:39], a[152:155], v[92:95], v[36:39]
    v_mfma_f32_16x16x32_bf16 v[40:43], a[156:159], v[92:95], v[40:43]
    buffer_load_dwordx4 v[124:127], v1, s[32:35], s17 offen offset:3072 sc1
    s_waitcnt vmcnt(7)
    v_mfma_f32_16x16x32_bf16 v[24:27], a[160:163], v[96:99], v[24:27]
    v_mfma_f32_16x16x32_bf16 v[28:31], a[164:167], v[96:99], v[28:31]
    v_mfma_f32_16x16x32_bf16 v[32:35], a[168:171], v[96:99], v[32:35]
    v_mfma_f32_16x16x32_bf16 v[36:39], a[172:175], v[96:99], v[36:39]
    buffer_load_dwordx4 v[128:131], v18, s[32:35], s17 offen offset:0 sc1
    v_mfma_f32_16x16x32_bf16 v[40:43], a[176:179], v[96:99], v[40:43]
    s_waitcnt vmcnt(7)
    v_mfma_f32_16x16x32_bf16 v[24:27], a[180:183], v[100:103], v[24:27]
    v_mfma_f32_16x16x32_bf16 v[28:31], a[184:187], v[100:103], v[28:31]
    v_mfma_f32_16x16x32_bf16 v[32:35], a[188:191], v[100:103], v[32:35]
    v_mfma_f32_16x16x32_bf16 v[36:39], a[192:195], v[100:103], v[36:39]
    buffer_load_dwordx4 v[132:135], v18, s[32:35], s17 offen offset:1024 sc1
    v_mfma_f32_16x16x32_bf16 v[40:43], a[196:199], v[100:103], v[40:43]
    s_waitcnt vmcnt(7)
    v_mfma_f32_16x16x32_bf16 v[24:27], a[200:203], v[104:107], v[24:27]
    v_mfma_f32_16x16x32_bf16 v[28:31], a[204:207], v[104:107], v[28:31]
    v_mfma_f32_16x16x32_bf16 v[32:35], a[208:211], v[104:107], v[32:35]
    v_mfma_f32_16x16x32_bf16 v[36:39], a[212:215], v[104:107], v[36:39]
    buffer_load_dwordx4 v[136:139], v18, s[32:35], s17 offen offset:2048 sc1
    v_mfma_f32_16x16x32_bf16 v[40:43], a[216:219], v[104:107], v[40:43]
    s_waitcnt vmcnt(7)
    v_mfma_f32_16x16x32_bf16 v[24:27], a[220:223], v[108:111], v[24:27]
    v_mfma_f32_16x16x32_bf16 v[28:31], a[224:227], v[108:111], v[28:31]
    v_mfma_f32_16x16x32_bf16 v[32:35], a[228:231], v[108:111], v[32:35]
    v_mfma_f32_16x16x32_bf16 v[36:39], a[232:235], v[108:111], v[36:39]
    buffer_load_dwordx4 v[140:143], v18, s[32:35], s17 offen offset:3072 sc1
    v_mfma_f32_16x16x32_bf16 v[40:43], a[236:239], v[108:111], v[40:43]
    s_waitcnt vmcnt(7)
    v_mfma_f32_16x16x32_bf16 v[44:47], a[0:3], v[112:115], 0
    v_mfma_f32_16x16x32_bf16 v[48:51], a[4:7], v[112:115], 0
    v_mfma_f32_16x16x32_bf16 v[52:55], a[8:11], v[112:115], 0
    buffer_load_dwordx4 v[144:147], v19, s[32:35], s17 offen offset:0 sc1
    ds_write_b128 v14, v[24:27] offset:0
    v_mfma_f32_16x16x32_bf16 v[56:59], a[12:15], v[112:115], 0
    ds_write_b128 v14, v[28:31] offset:1024
    v_mfma_f32_16x16x32_bf16 v[60:63], a[16:19], v[112:115], 0
    ds_write_b128 v14, v[32:35] offset:2048
    s_waitcnt vmcnt(7)
    v_mfma_f32_16x16x32_bf16 v[44:47], a[20:23], v[116:119], v[44:47]
    ds_write_b128 v14, v[36:39] offset:3072
    v_mfma_f32_16x16x32_bf16 v[48:51], a[24:27], v[116:119], v[48:51]
    buffer_load_dwordx4 v[148:151], v19, s[32:35], s17 offen offset:1024 sc1
    ds_write_b128 v14, v[40:43] offset:4096
    v_mfma_f32_16x16x32_bf16 v[52:55], a[28:31], v[116:119], v[52:55]
    v_mfma_f32_16x16x32_bf16 v[56:59], a[32:35], v[116:119], v[56:59]
    v_mfma_f32_16x16x32_bf16 v[60:63], a[36:39], v[116:119], v[60:63]
    s_waitcnt vmcnt(7)
    v_mfma_f32_16x16x32_bf16 v[44:47], a[40:43], v[120:123], v[44:47]
    v_mfma_f32_16x16x32_bf16 v[48:51], a[44:47], v[120:123], v[48:51]
    buffer_load_dwordx4 v[152:155], v19, s[32:35], s17 offen offset:2048 sc1
    v_mfma_f32_16x16x32_bf16 v[52:55], a[48:51], v[120:123], v[52:55]
    v_mfma_f32_16x16x32_bf16 v[56:59], a[52:55], v[120:123], v[56:59]
    v_mfma_f32_16x16x32_bf16 v[60:63], a[56:59], v[120:123], v[60:63]
    s_waitcnt vmcnt(7)
    v_mfma_f32_16x16x32_bf16 v[44:47], a[60:63], v[124:127], v[44:47]
    buffer_load_dwordx4 v[156:159], v19, s[32:35], s17 offen offset:3072 sc1
    v_mfma_f32_16x16x32_bf16 v[48:51], a[64:67], v[124:127], v[48:51]
    v_mfma_f32_16x16x32_bf16 v[52:55], a[68:71], v[124:127], v[52:55]
    v_mfma_f32_16x16x32_bf16 v[56:59], a[72:75], v[124:127], v[56:59]
    v_mfma_f32_16x16x32_bf16 v[60:63], a[76:79], v[124:127], v[60:63]
    s_waitcnt vmcnt(7)
    v_mfma_f32_16x16x32_bf16 v[44:47], a[80:83], v[128:131], v[44:47]
    buffer_load_dwordx4 v[160:163], v1, s[32:35], s18 offen offset:0 sc1
    v_mfma_f32_16x16x32_bf16 v[48:51], a[84:87], v[128:131], v[48:51]
    v_mfma_f32_16x16x32_bf16 v[52:55], a[88:91], v[128:131], v[52:55]
    v_mfma_f32_16x16x32_bf16 v[56:59], a[92:95], v[128:131], v[56:59]
    v_mfma_f32_16x16x32_bf16 v[60:63], a[96:99], v[128:131], v[60:63]
    s_waitcnt vmcnt(7)
    v_mfma_f32_16x16x32_bf16 v[44:47], a[100:103], v[132:135], v[44:47]
    buffer_load_dwordx4 v[164:167], v1, s[32:35], s18 offen offset:1024 sc1
    v_mfma_f32_16x16x32_bf16 v[48:51], a[104:107], v[132:135], v[48:51]
    v_mfma_f32_16x16x32_bf16 v[52:55], a[108:111], v[132:135], v[52:55]
    v_mfma_f32_16x16x32_bf16 v[56:59], a[112:115], v[132:135], v[56:59]
    v_mfma_f32_16x16x32_bf16 v[60:63], a[116:119], v[132:135], v[60:63]
    s_waitcnt vmcnt(7)
    v_mfma_f32_16x16x32_bf16 v[44:47], a[120:123], v[136:139], v[44:47]
    buffer_load_dwordx4 v[168:171], v1, s[32:35], s18 offen offset:2048 sc1
    v_mfma_f32_16x16x32_bf16 v[48:51], a[124:127], v[136:139], v[48:51]
    v_mfma_f32_16x16x32_bf16 v[52:55], a[128:131], v[136:139], v[52:55]
    v_mfma_f32_16x16x32_bf16 v[56:59], a[132:135], v[136:139], v[56:59]
    v_mfma_f32_16x16x32_bf16 v[60:63], a[136:139], v[136:139], v[60:63]
    s_waitcnt vmcnt(7)
    v_mfma_f32_16x16x32_bf16 v[44:47], a[140:143], v[140:143], v[44:47]
    buffer_load_dwordx4 v[172:175], v1, s[32:35], s18 offen offset:3072 sc1
    v_mfma_f32_16x16x32_bf16 v[48:51], a[144:147], v[140:143], v[48:51]
    v_mfma_f32_16x16x32_bf16 v[52:55], a[148:151], v[140:143], v[52:55]
    v_mfma_f32_16x16x32_bf16 v[56:59], a[152:155], v[140:143], v[56:59]
    v_mfma_f32_16x16x32_bf16 v[60:63], a[156:159], v[140:143], v[60:63]
    buffer_load_dwordx4 v[176:179], v18, s[32:35], s18 offen offset:0 sc1
    s_waitcnt vmcnt(8)
    v_mfma_f32_16x16x32_bf16 v[44:47], a[160:163], v[144:147], v[44:47]
    v_mfma_f32_16x16x32_bf16 v[48:51], a[164:167], v[144:147], v[48:51]
    v_mfma_f32_16x16x32_bf16 v[52:55], a[168:171], v[144:147], v[52:55]
    v_mfma_f32_16x16x32_bf16 v[56:59], a[172:175], v[144:147], v[56:59]
    v_mfma_f32_16x16x32_bf16 v[60:63], a[176:179], v[144:147], v[60:63]
    buffer_load_dwordx4 v[180:183], v18, s[32:35], s18 offen offset:1024 sc1
    s_waitcnt vmcnt(8)
    v_mfma_f32_16x16x32_bf16 v[44:47], a[180:183], v[148:151], v[44:47]
    v_mfma_f32_16x16x32_bf16 v[48:51], a[184:187], v[148:151], v[48:51]
    v_mfma_f32_16x16x32_bf16 v[52:55], a[188:191], v[148:151], v[52:55]
    v_mfma_f32_16x16x32_bf16 v[56:59], a[192:195], v[148:151], v[56:59]
    v_mfma_f32_16x16x32_bf16 v[60:63], a[196:199], v[148:151], v[60:63]
    buffer_load_dwordx4 v[184:187], v18, s[32:35], s18 offen offset:2048 sc1
    s_waitcnt vmcnt(8)
    v_mfma_f32_16x16x32_bf16 v[44:47], a[200:203], v[152:155], v[44:47]
    v_mfma_f32_16x16x32_bf16 v[48:51], a[204:207], v[152:155], v[48:51]
    v_mfma_f32_16x16x32_bf16 v[52:55], a[208:211], v[152:155], v[52:55]
    v_mfma_f32_16x16x32_bf16 v[56:59], a[212:215], v[152:155], v[56:59]
    v_mfma_f32_16x16x32_bf16 v[60:63], a[216:219], v[152:155], v[60:63]
    buffer_load_dwordx4 v[188:191], v18, s[32:35], s18 offen offset:3072 sc1
    s_waitcnt vmcnt(8)
    v_mfma_f32_16x16x32_bf16 v[44:47], a[220:223], v[156:159], v[44:47]
    v_mfma_f32_16x16x32_bf16 v[48:51], a[224:227], v[156:159], v[48:51]
    v_mfma_f32_16x16x32_bf16 v[52:55], a[228:231], v[156:159], v[52:55]
    v_mfma_f32_16x16x32_bf16 v[56:59], a[232:235], v[156:159], v[56:59]
    buffer_load_dwordx4 v[192:195], v19, s[32:35], s18 offen offset:0 sc1
    v_mfma_f32_16x16x32_bf16 v[60:63], a[236:239], v[156:159], v[60:63]
    s_waitcnt vmcnt(8)
    v_mfma_f32_16x16x32_bf16 v[24:27], a[0:3], v[160:163], 0
    v_mfma_f32_16x16x32_bf16 v[28:31], a[4:7], v[160:163], 0
    v_mfma_f32_16x16x32_bf16 v[32:35], a[8:11], v[160:163], 0
    ds_write_b128 v15, v[44:47] offset:0
    v_mfma_f32_16x16x32_bf16 v[36:39], a[12:15], v[160:163], 0
    buffer_load_dwordx4 v[196:199], v19, s[32:35], s18 offen offset:1024 sc1
    ds_write_b128 v15, v[48:51] offset:1024
    v_mfma_f32_16x16x32_bf16 v[40:43], a[16:19], v[160:163], 0
    ds_write_b128 v15, v[52:55] offset:2048
    s_waitcnt vmcnt(8)
    v_mfma_f32_16x16x32_bf16 v[24:27], a[20:23], v[164:167], v[24:27]
    ds_write_b128 v15, v[56:59] offset:3072
    v_mfma_f32_16x16x32_bf16 v[28:31], a[24:27], v[164:167], v[28:31]
    ds_write_b128 v15, v[60:63] offset:4096
    v_mfma_f32_16x16x32_bf16 v[32:35], a[28:31], v[164:167], v[32:35]
    buffer_load_dwordx4 v[200:203], v19, s[32:35], s18 offen offset:2048 sc1
    v_accvgpr_read_b32 v4, a240
    v_accvgpr_read_b32 v5, a241
    v_mfma_f32_16x16x32_bf16 v[36:39], a[32:35], v[164:167], v[36:39]
    v_accvgpr_read_b32 v6, a242
    v_accvgpr_read_b32 v7, a243
    v_mfma_f32_16x16x32_bf16 v[40:43], a[36:39], v[164:167], v[40:43]
    v_accvgpr_read_b32 v8, a244
    v_accvgpr_read_b32 v9, a245
    s_waitcnt vmcnt(8)
    v_mfma_f32_16x16x32_bf16 v[24:27], a[40:43], v[168:171], v[24:27]
    buffer_load_dwordx4 v[204:207], v19, s[32:35], s18 offen offset:3072 sc1
    v_accvgpr_read_b32 v10, a246
    v_accvgpr_read_b32 v11, a247
    v_mfma_f32_16x16x32_bf16 v[28:31], a[44:47], v[168:171], v[28:31]
    v_accvgpr_read_b32 v12, a248
    v_accvgpr_read_b32 v13, a249
    v_mfma_f32_16x16x32_bf16 v[32:35], a[48:51], v[168:171], v[32:35]
    v_accvgpr_read_b32 v2, a250
    v_lshlrev_b32 v124, 16, v4
    v_mfma_f32_16x16x32_bf16 v[36:39], a[52:55], v[168:171], v[36:39]
    buffer_load_dwordx4 v[208:211], v1, s[32:35], s19 offen offset:0 sc1
    v_and_b32 v125, 0xffff0000, v4
    v_lshlrev_b32 v126, 16, v5
    v_mfma_f32_16x16x32_bf16 v[40:43], a[56:59], v[168:171], v[40:43]
    v_and_b32 v127, 0xffff0000, v5
    v_lshlrev_b32 v128, 16, v6
    s_waitcnt vmcnt(9)
    v_mfma_f32_16x16x32_bf16 v[24:27], a[60:63], v[172:175], v[24:27]
    v_and_b32 v129, 0xffff0000, v6
    v_lshlrev_b32 v130, 16, v7
    v_mfma_f32_16x16x32_bf16 v[28:31], a[64:67], v[172:175], v[28:31]
    v_and_b32 v131, 0xffff0000, v7
    buffer_load_dwordx4 v[212:215], v1, s[32:35], s19 offen offset:1024 sc1
    v_lshlrev_b32 v132, 16, v8
    v_mfma_f32_16x16x32_bf16 v[32:35], a[68:71], v[172:175], v[32:35]
    v_and_b32 v133, 0xffff0000, v8
    v_lshlrev_b32 v134, 16, v9
    v_mfma_f32_16x16x32_bf16 v[36:39], a[72:75], v[172:175], v[36:39]
    v_and_b32 v135, 0xffff0000, v9
    v_lshlrev_b32 v136, 16, v10
    v_mfma_f32_16x16x32_bf16 v[40:43], a[76:79], v[172:175], v[40:43]
    v_and_b32 v137, 0xffff0000, v10
    v_lshlrev_b32 v138, 16, v11
    s_waitcnt vmcnt(9)
    v_mfma_f32_16x16x32_bf16 v[24:27], a[80:83], v[176:179], v[24:27]
    buffer_load_dwordx4 v[216:219], v1, s[32:35], s19 offen offset:2048 sc1
    v_and_b32 v139, 0xffff0000, v11
    v_lshlrev_b32 v140, 16, v12
    v_mfma_f32_16x16x32_bf16 v[28:31], a[84:87], v[176:179], v[28:31]
    v_and_b32 v141, 0xffff0000, v12
    v_lshlrev_b32 v142, 16, v13
    v_mfma_f32_16x16x32_bf16 v[32:35], a[88:91], v[176:179], v[32:35]
    v_and_b32 v143, 0xffff0000, v13
    v_mfma_f32_16x16x32_bf16 v[36:39], a[92:95], v[176:179], v[36:39]
    buffer_load_dwordx4 v[220:223], v1, s[32:35], s19 offen offset:3072 sc1
    v_mfma_f32_16x16x32_bf16 v[40:43], a[96:99], v[176:179], v[40:43]
    s_waitcnt vmcnt(10)
    v_mfma_f32_16x16x32_bf16 v[24:27], a[100:103], v[180:183], v[24:27]
    v_mfma_f32_16x16x32_bf16 v[28:31], a[104:107], v[180:183], v[28:31]
    v_mfma_f32_16x16x32_bf16 v[32:35], a[108:111], v[180:183], v[32:35]
    v_mfma_f32_16x16x32_bf16 v[36:39], a[112:115], v[180:183], v[36:39]
    buffer_load_dwordx4 v[224:227], v18, s[32:35], s19 offen offset:0 sc1
    v_mfma_f32_16x16x32_bf16 v[40:43], a[116:119], v[180:183], v[40:43]
    s_waitcnt vmcnt(10)
    v_mfma_f32_16x16x32_bf16 v[24:27], a[120:123], v[184:187], v[24:27]
    v_mfma_f32_16x16x32_bf16 v[28:31], a[124:127], v[184:187], v[28:31]
    v_mfma_f32_16x16x32_bf16 v[32:35], a[128:131], v[184:187], v[32:35]
    v_mfma_f32_16x16x32_bf16 v[36:39], a[132:135], v[184:187], v[36:39]
    buffer_load_dwordx4 v[228:231], v18, s[32:35], s19 offen offset:1024 sc1
    v_mfma_f32_16x16x32_bf16 v[40:43], a[136:139], v[184:187], v[40:43]
    s_waitcnt vmcnt(10)
    v_mfma_f32_16x16x32_bf16 v[24:27], a[140:143], v[188:191], v[24:27]
    v_mfma_f32_16x16x32_bf16 v[28:31], a[144:147], v[188:191], v[28:31]
    v_mfma_f32_16x16x32_bf16 v[32:35], a[148:151], v[188:191], v[32:35]
    buffer_load_dwordx4 v[232:235], v18, s[32:35], s19 offen offset:2048 sc1
    v_mfma_f32_16x16x32_bf16 v[36:39], a[152:155], v[188:191], v[36:39]
    v_mfma_f32_16x16x32_bf16 v[40:43], a[156:159], v[188:191], v[40:43]
    s_waitcnt vmcnt(10)
    v_mfma_f32_16x16x32_bf16 v[24:27], a[160:163], v[192:195], v[24:27]
    v_mfma_f32_16x16x32_bf16 v[28:31], a[164:167], v[192:195], v[28:31]
    v_mfma_f32_16x16x32_bf16 v[32:35], a[168:171], v[192:195], v[32:35]
    buffer_load_dwordx4 v[236:239], v18, s[32:35], s19 offen offset:3072 sc1
    v_mfma_f32_16x16x32_bf16 v[36:39], a[172:175], v[192:195], v[36:39]
    v_mfma_f32_16x16x32_bf16 v[40:43], a[176:179], v[192:195], v[40:43]
    s_waitcnt vmcnt(10)
    v_mfma_f32_16x16x32_bf16 v[24:27], a[180:183], v[196:199], v[24:27]
    v_mfma_f32_16x16x32_bf16 v[28:31], a[184:187], v[196:199], v[28:31]
    v_mfma_f32_16x16x32_bf16 v[32:35], a[188:191], v[196:199], v[32:35]
    buffer_load_dwordx4 v[240:243], v19, s[32:35], s19 offen offset:0 sc1
    v_mfma_f32_16x16x32_bf16 v[36:39], a[192:195], v[196:199], v[36:39]
    v_mfma_f32_16x16x32_bf16 v[40:43], a[196:199], v[196:199], v[40:43]
    s_waitcnt vmcnt(10)
    v_mfma_f32_16x16x32_bf16 v[24:27], a[200:203], v[200:203], v[24:27]
    v_mfma_f32_16x16x32_bf16 v[28:31], a[204:207], v[200:203], v[28:31]
    v_mfma_f32_16x16x32_bf16 v[32:35], a[208:211], v[200:203], v[32:35]
    buffer_load_dwordx4 v[244:247], v19, s[32:35], s19 offen offset:1024 sc1
    v_mfma_f32_16x16x32_bf16 v[36:39], a[212:215], v[200:203], v[36:39]
    v_mfma_f32_16x16x32_bf16 v[40:43], a[216:219], v[200:203], v[40:43]
    s_waitcnt vmcnt(10)
    v_mfma_f32_16x16x32_bf16 v[24:27], a[220:223], v[204:207], v[24:27]
    v_mfma_f32_16x16x32_bf16 v[28:31], a[224:227], v[204:207], v[28:31]
    buffer_load_dwordx4 v[248:251], v19, s[32:35], s19 offen offset:2048 sc1
    v_mfma_f32_16x16x32_bf16 v[32:35], a[228:231], v[204:207], v[32:35]
    v_mfma_f32_16x16x32_bf16 v[36:39], a[232:235], v[204:207], v[36:39]
    v_mfma_f32_16x16x32_bf16 v[40:43], a[236:239], v[204:207], v[40:43]
    s_waitcnt vmcnt(10)
    v_mfma_f32_16x16x32_bf16 v[44:47], a[0:3], v[208:211], 0
    v_mfma_f32_16x16x32_bf16 v[48:51], a[4:7], v[208:211], 0
    buffer_load_dwordx4 v[252:255], v19, s[32:35], s19 offen offset:3072 sc1
    v_mfma_f32_16x16x32_bf16 v[52:55], a[8:11], v[208:211], 0
    ds_write_b128 v16, v[24:27] offset:0
    v_mfma_f32_16x16x32_bf16 v[56:59], a[12:15], v[208:211], 0
    ds_write_b128 v16, v[28:31] offset:1024
    v_mfma_f32_16x16x32_bf16 v[60:63], a[16:19], v[208:211], 0
    ds_write_b128 v16, v[32:35] offset:2048
    s_waitcnt vmcnt(10)
    v_mfma_f32_16x16x32_bf16 v[44:47], a[20:23], v[212:215], v[44:47]
    ds_write_b128 v16, v[36:39] offset:3072
    v_mfma_f32_16x16x32_bf16 v[48:51], a[24:27], v[212:215], v[48:51]
    ds_write_b128 v16, v[40:43] offset:4096
    v_mfma_f32_16x16x32_bf16 v[52:55], a[28:31], v[212:215], v[52:55]
    v_mfma_f32_16x16x32_bf16 v[56:59], a[32:35], v[212:215], v[56:59]
    v_mfma_f32_16x16x32_bf16 v[60:63], a[36:39], v[212:215], v[60:63]
    s_waitcnt vmcnt(9)
    v_mfma_f32_16x16x32_bf16 v[44:47], a[40:43], v[216:219], v[44:47]
    v_mfma_f32_16x16x32_bf16 v[48:51], a[44:47], v[216:219], v[48:51]
    v_mfma_f32_16x16x32_bf16 v[52:55], a[48:51], v[216:219], v[52:55]
    v_mfma_f32_16x16x32_bf16 v[56:59], a[52:55], v[216:219], v[56:59]
    v_mfma_f32_16x16x32_bf16 v[60:63], a[56:59], v[216:219], v[60:63]
    s_waitcnt lgkmcnt(0)
    s_barrier
    s_waitcnt vmcnt(8)
    v_mfma_f32_16x16x32_bf16 v[44:47], a[60:63], v[220:223], v[44:47]
    ds_read_b128 v[64:67], v17 offset:0
    v_mfma_f32_16x16x32_bf16 v[48:51], a[64:67], v[220:223], v[48:51]
    ds_read_b128 v[68:71], v17 offset:1024
    v_mfma_f32_16x16x32_bf16 v[52:55], a[68:71], v[220:223], v[52:55]
    ds_read_b128 v[72:75], v17 offset:2048
    v_mfma_f32_16x16x32_bf16 v[56:59], a[72:75], v[220:223], v[56:59]
    ds_read_b128 v[76:79], v17 offset:3072
    v_mfma_f32_16x16x32_bf16 v[60:63], a[76:79], v[220:223], v[60:63]
    ds_read_b128 v[80:83], v17 offset:4096
    s_waitcnt vmcnt(7)
    v_mfma_f32_16x16x32_bf16 v[44:47], a[80:83], v[224:227], v[44:47]
    ds_read_b128 v[84:87], v17 offset:5120
    v_mfma_f32_16x16x32_bf16 v[48:51], a[84:87], v[224:227], v[48:51]
    ds_read_b128 v[88:91], v17 offset:6144
    v_mfma_f32_16x16x32_bf16 v[52:55], a[88:91], v[224:227], v[52:55]
    ds_read_b128 v[92:95], v17 offset:7168
    v_mfma_f32_16x16x32_bf16 v[56:59], a[92:95], v[224:227], v[56:59]
    ds_read_b128 v[96:99], v17 offset:8192
    v_mfma_f32_16x16x32_bf16 v[60:63], a[96:99], v[224:227], v[60:63]
    ds_read_b128 v[100:103], v17 offset:9216
    s_waitcnt vmcnt(6)
    v_mfma_f32_16x16x32_bf16 v[44:47], a[100:103], v[228:231], v[44:47]
    ds_read_b128 v[104:107], v17 offset:10240
    v_mfma_f32_16x16x32_bf16 v[48:51], a[104:107], v[228:231], v[48:51]
    ds_read_b128 v[108:111], v17 offset:11264
    v_mfma_f32_16x16x32_bf16 v[52:55], a[108:111], v[228:231], v[52:55]
    ds_read_b128 v[112:115], v17 offset:12288
    v_mfma_f32_16x16x32_bf16 v[56:59], a[112:115], v[228:231], v[56:59]
    ds_read_b128 v[116:119], v17 offset:13312
    v_mfma_f32_16x16x32_bf16 v[60:63], a[116:119], v[228:231], v[60:63]
    ds_read_b128 v[120:123], v17 offset:14336
    s_waitcnt vmcnt(5)
    v_mfma_f32_16x16x32_bf16 v[44:47], a[120:123], v[232:235], v[44:47]
    v_mfma_f32_16x16x32_bf16 v[48:51], a[124:127], v[232:235], v[48:51]
    v_mfma_f32_16x16x32_bf16 v[52:55], a[128:131], v[232:235], v[52:55]
    v_mfma_f32_16x16x32_bf16 v[56:59], a[132:135], v[232:235], v[56:59]
    v_mfma_f32_16x16x32_bf16 v[60:63], a[136:139], v[232:235], v[60:63]
    s_waitcnt vmcnt(4)
    v_mfma_f32_16x16x32_bf16 v[44:47], a[140:143], v[236:239], v[44:47]
    v_mfma_f32_16x16x32_bf16 v[48:51], a[144:147], v[236:239], v[48:51]
    v_mfma_f32_16x16x32_bf16 v[52:55], a[148:151], v[236:239], v[52:55]
    v_mfma_f32_16x16x32_bf16 v[56:59], a[152:155], v[236:239], v[56:59]
    v_mfma_f32_16x16x32_bf16 v[60:63], a[156:159], v[236:239], v[60:63]
    s_waitcnt vmcnt(3)
    v_mfma_f32_16x16x32_bf16 v[44:47], a[160:163], v[240:243], v[44:47]
    v_mfma_f32_16x16x32_bf16 v[48:51], a[164:167], v[240:243], v[48:51]
    v_mfma_f32_16x16x32_bf16 v[52:55], a[168:171], v[240:243], v[52:55]
    v_mfma_f32_16x16x32_bf16 v[56:59], a[172:175], v[240:243], v[56:59]
    v_mfma_f32_16x16x32_bf16 v[60:63], a[176:179], v[240:243], v[60:63]
    s_waitcnt vmcnt(2)
    v_mfma_f32_16x16x32_bf16 v[44:47], a[180:183], v[244:247], v[44:47]
    v_mfma_f32_16x16x32_bf16 v[48:51], a[184:187], v[244:247], v[48:51]
    v_mfma_f32_16x16x32_bf16 v[52:55], a[188:191], v[244:247], v[52:55]
    v_mfma_f32_16x16x32_bf16 v[56:59], a[192:195], v[244:247], v[56:59]
    v_mfma_f32_16x16x32_bf16 v[60:63], a[196:199], v[244:247], v[60:63]
    s_waitcnt vmcnt(1)
    v_mfma_f32_16x16x32_bf16 v[44:47], a[200:203], v[248:251], v[44:47]
    v_mfma_f32_16x16x32_bf16 v[48:51], a[204:207], v[248:251], v[48:51]
    v_mfma_f32_16x16x32_bf16 v[52:55], a[208:211], v[248:251], v[52:55]
    v_mfma_f32_16x16x32_bf16 v[56:59], a[212:215], v[248:251], v[56:59]
    v_mfma_f32_16x16x32_bf16 v[60:63], a[216:219], v[248:251], v[60:63]
    s_waitcnt vmcnt(0)
    v_mfma_f32_16x16x32_bf16 v[44:47], a[220:223], v[252:255], v[44:47]
    v_mfma_f32_16x16x32_bf16 v[48:51], a[224:227], v[252:255], v[48:51]
    v_mfma_f32_16x16x32_bf16 v[52:55], a[228:231], v[252:255], v[52:55]
    v_mfma_f32_16x16x32_bf16 v[56:59], a[232:235], v[252:255], v[56:59]
    v_mfma_f32_16x16x32_bf16 v[60:63], a[236:239], v[252:255], v[60:63]
    s_waitcnt lgkmcnt(10)
    v_pk_add_f32 v[124:125], v[124:125], v[64:65]
    v_pk_add_f32 v[126:127], v[126:127], v[66:67]
    v_pk_add_f32 v[128:129], v[128:129], v[68:69]
    v_pk_add_f32 v[130:131], v[130:131], v[70:71]
    v_pk_add_f32 v[132:133], v[132:133], v[72:73]
    v_pk_add_f32 v[134:135], v[134:135], v[74:75]
    v_pk_add_f32 v[136:137], v[136:137], v[76:77]
    v_pk_add_f32 v[138:139], v[138:139], v[78:79]
    v_pk_add_f32 v[140:141], v[140:141], v[80:81]
    v_pk_add_f32 v[142:143], v[142:143], v[82:83]
    s_waitcnt lgkmcnt(5)
    v_pk_add_f32 v[124:125], v[124:125], v[84:85]
    v_pk_add_f32 v[126:127], v[126:127], v[86:87]
    v_pk_add_f32 v[128:129], v[128:129], v[88:89]
    v_pk_add_f32 v[130:131], v[130:131], v[90:91]
    v_pk_add_f32 v[132:133], v[132:133], v[92:93]
    v_pk_add_f32 v[134:135], v[134:135], v[94:95]
    v_pk_add_f32 v[136:137], v[136:137], v[96:97]
    v_pk_add_f32 v[138:139], v[138:139], v[98:99]
    v_pk_add_f32 v[140:141], v[140:141], v[100:101]
    v_pk_add_f32 v[142:143], v[142:143], v[102:103]
    s_waitcnt lgkmcnt(0)
    v_pk_add_f32 v[124:125], v[124:125], v[104:105]
    v_pk_add_f32 v[126:127], v[126:127], v[106:107]
    v_pk_add_f32 v[128:129], v[128:129], v[108:109]
    v_pk_add_f32 v[130:131], v[130:131], v[110:111]
    v_pk_add_f32 v[132:133], v[132:133], v[112:113]
    v_pk_add_f32 v[134:135], v[134:135], v[114:115]
    v_pk_add_f32 v[136:137], v[136:137], v[116:117]
    v_pk_add_f32 v[138:139], v[138:139], v[118:119]
    v_pk_add_f32 v[140:141], v[140:141], v[120:121]
    v_pk_add_f32 v[142:143], v[142:143], v[122:123]
    v_pk_add_f32 v[124:125], v[124:125], v[44:45]
    v_pk_add_f32 v[126:127], v[126:127], v[46:47]
    v_pk_add_f32 v[128:129], v[128:129], v[48:49]
    v_pk_add_f32 v[130:131], v[130:131], v[50:51]
    v_pk_add_f32 v[132:133], v[132:133], v[52:53]
    v_pk_add_f32 v[134:135], v[134:135], v[54:55]
    v_pk_add_f32 v[136:137], v[136:137], v[56:57]
    v_pk_add_f32 v[138:139], v[138:139], v[58:59]
    v_pk_add_f32 v[140:141], v[140:141], v[60:61]
    v_pk_add_f32 v[142:143], v[142:143], v[62:63]
    v_cvt_pk_bf16_f32 v4, v124, v125
    v_cvt_pk_bf16_f32 v5, v126, v127
    v_cvt_pk_bf16_f32 v6, v128, v129
    v_cvt_pk_bf16_f32 v7, v130, v131
    v_cvt_pk_bf16_f32 v8, v132, v133
    v_cvt_pk_bf16_f32 v9, v134, v135
    v_cvt_pk_bf16_f32 v10, v136, v137
    v_cvt_pk_bf16_f32 v11, v138, v139
    v_cvt_pk_bf16_f32 v12, v140, v141
    v_cvt_pk_bf16_f32 v13, v142, v143
    buffer_store_dwordx4 v[4:7], v2, s[40:43], 0 offen
    buffer_store_dwordx4 v[8:11], v2, s[40:43], 0 offen offset:16
    buffer_store_dwordx2 v[12:13], v2, s[40:43], 0 offen offset:32
    s_endpgm
L_code_end:
    s_endpgm
.section .rodata,"a"
.p2align 6
.amdhsa_kernel sequential_preLN__linear_kernel_hedgehog__dense_activation_relu__prompt_kernel
  .amdhsa_next_free_vgpr 512
  .amdhsa_next_free_sgpr 102
  .amdhsa_accum_offset 256
  .amdhsa_group_segment_fixed_size 0
  .amdhsa_kernarg_size 80
  .amdhsa_user_sgpr_count 2
  .amdhsa_user_sgpr_kernarg_segment_ptr 1
  .amdhsa_system_sgpr_workgroup_id_x 1
.end_amdhsa_kernel
```
